```python
import torch

def _softmax(x, axis=-1):
    return torch.softmax(x, dim=axis)
def _gelu(x):
    return torch.nn.functional.gelu(x, approximate="tanh")
def _silu(x):
    return torch.nn.functional.silu(x)
def _sigmoid(x):
    return torch.sigmoid(x)
def _layernorm(x, axis=-1, eps=1e-5):
    m = x.mean(dim=axis, keepdim=True)
    v = x.var(dim=axis, keepdim=True, unbiased=False)
    return (x - m) / torch.sqrt(v + eps)
def _scatter_add(tgt, idx, src, axis=0):
    return tgt.clone().index_add_(axis, idx, src)
def _segment_sum(src, seg, n):
    out = torch.zeros((n,) + src.shape[1:], dtype=src.dtype)
    return out.index_add_(0, seg, src)
def _pad(x, pw):
    flat = tuple(v for pair in reversed(pw) for v in pair)
    return torch.nn.functional.pad(x, flat)

kernel_name = 'recurrent_scan__compressed_kv_cla__geglu_ffn__decode'

def setup_inputs():

    _w = (lambda a: (lambda t: t.to(torch.bfloat16) if t.is_floating_point() else t)(torch.as_tensor(a)))
    def _A_setup():
        B, H, Sq, Sk, D, M = 1, 32, 1, 8192, 128, 640
        Dc = 4 * D
        return {
            "x": _w((lambda *s: torch.randn(*s, dtype=torch.bfloat16) * 0.05)(B, Sq, M)),
            "c_kv": _w((lambda *s: torch.randn(*s, dtype=torch.bfloat16) * 0.8)(B, Sk, Dc)),
            "w_q": _w((lambda *s: torch.randn(*s, dtype=torch.bfloat16) * 1.6)(M, H, D) * (M ** -0.5)),
            "w_uk": _w((lambda *s: torch.randn(*s, dtype=torch.bfloat16) * 1.6)(Dc, H, D) * (Dc ** -0.5)),
            "w_uv": _w((lambda *s: torch.randn(*s, dtype=torch.bfloat16) * 0.8)(Dc, H, D) * (Dc ** -0.5)),
            "w_o": _w((lambda *s: torch.randn(*s, dtype=torch.bfloat16) * 0.8)(H, D, M) * ((H * D) ** -0.5)),
        }
    _A_in = _A_setup()

    def _B_setup():
        B, S, D, F = 1, 1, 640, 1728
        return {
            "x": _w((lambda *s: torch.randn(*s, dtype=torch.bfloat16) * 0.05)(B, S, D)),
            "w_gate": _w((lambda *s: torch.randn(*s, dtype=torch.bfloat16) * 0.2)(D, F)),
            "w_up": _w((lambda *s: torch.randn(*s, dtype=torch.bfloat16) * 0.2)(D, F)),
            "w_down": _w((lambda *s: torch.randn(*s, dtype=torch.bfloat16) * 0.2)(F, D)),
        }
    _B_in = _B_setup()

    return {
        "A_x": _A_in["x"],
        "A_c_kv": _A_in["c_kv"],
        "A_w_q": _A_in["w_q"],
        "A_w_uk": _A_in["w_uk"],
        "A_w_uv": _A_in["w_uv"],
        "A_w_o": _A_in["w_o"],
        "B_x": _B_in["x"],
        "B_w_gate": _B_in["w_gate"],
        "B_w_up": _B_in["w_up"],
        "B_w_down": _B_in["w_down"],
    }

def reference(A_x, A_c_kv, A_w_q, A_w_uk, A_w_uv, A_w_o, B_x, B_w_gate, B_w_up, B_w_down):
    def _A_ref(x, c_kv, w_q, w_uk, w_uv, w_o):
        B, Sq, M = x.shape[0], x.shape[1], x.shape[2]
        Sk = c_kv.shape[1]
        H, D = w_q.shape[1], w_q.shape[2]
        q = torch.einsum("bqm,mhd->bhqd", x, w_q)
        k = torch.einsum("bkc,chd->bhkd", c_kv, w_uk)
        v = torch.einsum("bkc,chd->bhkd", c_kv, w_uv)
        scores = torch.einsum("bhqd,bhkd->bhqk", q, k) * (D ** -0.5)
        off = Sk - Sq
        qi = torch.arange(Sq)[:, None]
        kj = torch.arange(Sk)[None, :]
        cmask = kj <= (qi + off)
        scores = torch.where(cmask[None, None], scores, -1e9)
        p = _softmax(scores, axis=-1)
        ctx = torch.einsum("bhqk,bhkd->bhqd", p, v)
        return torch.einsum("bhqd,hdm->bqm", ctx, w_o)

    def _B_ref(x, w_gate, w_up, w_down):
        return (_gelu(x @ w_gate) * (x @ w_up)) @ w_down

    x = A_x
    xn = _layernorm(x, axis=-1)
    s = _A_ref(xn, A_c_kv, A_w_q, A_w_uk, A_w_uv, A_w_o)
    g = _silu(_B_ref(xn, B_w_gate, B_w_up, B_w_down))
    return x + s * g
```

```asm
; @launch grid=(256,1,1) block=(256,1,1) lds=152832
.amdgcn_target "amdgcn-amd-amdhsa--gfx950"
.text
.globl recurrent_scan__compressed_kv_cla__geglu_ffn__decode_kernel
.p2align 8
.type recurrent_scan__compressed_kv_cla__geglu_ffn__decode_kernel,@function
recurrent_scan__compressed_kv_cla__geglu_ffn__decode_kernel:
    s_cmp_ge_u32 s2, 256
    s_cbranch_scc1 L_END
    s_load_dwordx2 s[8:9], s[0:1], 0
    s_load_dwordx2 s[12:13], s[0:1], 16
    s_load_dwordx2 s[24:25], s[0:1], 96
    s_load_dwordx2 s[16:17], s[0:1], 24
    s_load_dwordx2 s[20:21], s[0:1], 8
    s_getpc_b64 s[44:45]
L_PC:
    s_sub_u32 s44, s44, L_PC-recurrent_scan__compressed_kv_cla__geglu_ffn__decode_kernel
    s_subb_u32 s45, s45, 0
    s_mov_b32 s46, L_CODE_END-recurrent_scan__compressed_kv_cla__geglu_ffn__decode_kernel
    s_mov_b32 s47, 0x20000
    v_lshrrev_b32 v9, 4, v0
    v_and_b32 v9, 12, v9
    v_and_or_b32 v9, v0, 3, v9
    v_lshlrev_b32 v9, 7, v9
    s_bfe_u32 s6, s2, 0x30003
    s_lshl_b32 s6, s6, 11
    s_mov_b64 exec, 0xf
    buffer_load_dword v218, v9, s[44:47], s6 offen
    s_mov_b64 exec, -1
    v_and_b32 v1, 63, v0
    v_lshrrev_b32 v2, 6, v0
    s_mov_b32 s10, 0x500
    s_mov_b32 s11, 0x20000
    v_readfirstlane_b32 s3, v2
    v_and_b32 v2, 15, v1
    v_lshrrev_b32 v3, 4, v1
    v_mul_u32_u24 v9, 20, v1
    s_and_b32 s4, s2, 7
    s_lshl_b32 s4, s4, 2
    s_bfe_u32 s5, s2, 0x20005
    s_add_u32 s4, s4, s5
    s_bfe_u32 s5, s2, 0x20003
    s_mul_i32 s6, s5, 160
    s_mul_i32 s7, s3, 40
    s_add_u32 s51, s6, s7
    s_mov_b32 s14, 0x500000
    s_mov_b32 s15, 0x20000
    s_lshr_b32 s6, s2, 7
    s_mul_i32 s7, s6, 5
    s_add_u32 s7, s7, s51
    s_lshl_b32 s54, s7, 13
    s_lshl_b32 s53, s4, 8
    s_add_u32 s54, s54, s53
    v_mul_u32_u24 v11, 81920, v3
    v_lshl_add_u32 v11, v2, 4, v11
    s_waitcnt lgkmcnt(0)
    buffer_load_dwordx4 v[212:215], v9, s[8:11], 0 offen
    buffer_load_dword v216, v9, s[8:11], 0 offen offset:16
    buffer_load_dwordx4 v[64:67], v11, s[12:15], s54 offen
    s_add_u32 s54, s54, 8192
    buffer_load_dwordx4 v[68:71], v11, s[12:15], s54 offen
    s_add_u32 s54, s54, 8192
    buffer_load_dwordx4 v[72:75], v11, s[12:15], s54 offen
    s_add_u32 s54, s54, 8192
    buffer_load_dwordx4 v[76:79], v11, s[12:15], s54 offen
    s_add_u32 s54, s54, 8192
    buffer_load_dwordx4 v[80:83], v11, s[12:15], s54 offen
    s_load_dword s40, s[24:25], 0
    s_mov_b32 s26, 0x10000000
    s_mov_b32 s27, 0x20000
    s_mov_b32 s18, 0x400000
    s_mov_b32 s19, 0x20000
    s_lshl_b32 s6, s6, 2
    s_add_u32 s6, s6, s5
    s_lshl_b32 s6, s6, 9
    s_lshl_b32 s7, s4, 12
    s_add_u32 s6, s6, s7
    s_add_u32 s54, s6, 1703936
    s_add_u32 s55, s6, 1835008
    s_lshl_b32 s7, s3, 7
    s_add_u32 s6, s54, s7
    s_mov_b64 exec, 1
    buffer_load_dword v217, v9, s[24:27], s6 offen
    s_mov_b64 exec, -1
    v_and_b32 v9, 2, v3
    v_xor_b32 v9, v9, v2
    v_lshlrev_b32 v9, 4, v9
    v_lshl_add_u32 v36, v3, 13, v9
    v_xor_b32 v37, 64, v36
    v_xor_b32 v38, 128, v36
    v_xor_b32 v39, 192, v36
    s_lshl_b32 s6, s5, 7
    s_lshl_b32 s7, s3, 5
    s_add_u32 s6, s6, s7
    s_lshl_b32 s6, s6, 13
    s_add_u32 s62, s6, s53
    s_cmp_ge_u32 s2, 128
    s_cselect_b32 s62, 0x7000000, s62
    s_cselect_b64 s[30:31], -1, 0
    s_cselect_b32 s63, 15, 13
    s_lshl_b32 s63, s3, s63
    s_mov_b32 s22, 0x800000
    s_mov_b32 s23, 0x20000
    s_and_b32 s61, s2, 7
    s_bfe_u32 s6, s2, 0x30004
    s_lshl_b32 s6, s6, 3
    s_or_b32 s61, s61, s6
    s_bfe_u32 s58, s2, 0x10003
    s_lshl_b32 s56, s61, 17
    s_lshl_b32 s57, s3, 15
    s_add_u32 s56, s56, s57
    s_mul_i32 s60, s58, 16384
    s_add_u32 s56, s56, s60
    v_xor_b32 v9, 0, v1
    v_lshlrev_b32 v9, 4, v9
    v_cndmask_b32 v224, v36, v9, s[30:31]
    v_xor_b32 v9, 2, v1
    v_lshlrev_b32 v9, 4, v9
    v_cndmask_b32 v225, v37, v9, s[30:31]
    v_xor_b32 v9, 4, v1
    v_lshlrev_b32 v9, 4, v9
    v_cndmask_b32 v226, v38, v9, s[30:31]
    v_xor_b32 v9, 6, v1
    v_lshlrev_b32 v9, 4, v9
    v_cndmask_b32 v227, v39, v9, s[30:31]
    s_cmp_ge_u32 s2, 128
    s_cselect_b64 s[16:17], s[20:21], s[16:17]
    s_cselect_b32 s18, s22, s18
    s_cselect_b32 s65, 10, 15
    s_lshl_b32 s65, 1, s65
    s_mov_b32 s41, 40000
    v_and_b32 v9, 1, v2
    v_lshlrev_b32 v9, 4, v9
    v_mov_b32 v10, 0xffff
    v_lshlrev_b32 v9, v9, v10
    v_bfe_u32 v10, v2, 1, 2
    v_cmp_eq_u32 s[42:43], 0, v10
    v_cmp_eq_u32 s[44:45], 1, v10
    v_cmp_eq_u32 s[46:47], 2, v10
    v_cmp_eq_u32 s[48:49], 3, v10
    v_mov_b32 v8, 0xff
    v_cndmask_b32 v4, 0, v9, s[42:43]
    v_cndmask_b32 v5, 0, v9, s[44:45]
    v_cndmask_b32 v6, 0, v9, s[46:47]
    v_cndmask_b32 v7, 0, v9, s[48:49]
    v_and_b32 v9, 1, v3
    v_lshlrev_b32 v9, 4, v9
    v_lshl_add_u32 v14, v2, 5, v9
    s_lshl_b32 s7, s3, 9
    v_add_u32 v15, s7, v14
    v_add_u32 v12, 147456, v15
    v_lshlrev_b32 v204, 4, v1
    v_add_u32 v13, 147456, v204
    s_lshl_b32 s6, s5, 2
    s_add_u32 s6, s6, s3
    s_lshl_b32 s6, s6, 4
    v_lshl_add_u32 v10, v3, 2, s6
    s_waitcnt vmcnt(6)
    ds_bpermute_b32 v40, v10, v212
    ds_bpermute_b32 v41, v10, v213
    ds_bpermute_b32 v42, v10, v214
    ds_bpermute_b32 v43, v10, v215
    ds_bpermute_b32 v44, v10, v216
    v_lshlrev_b32 v48, 16, v212
    v_and_b32 v49, 0xffff0000, v212
    v_lshlrev_b32 v50, 16, v213
    v_and_b32 v51, 0xffff0000, v213
    v_lshlrev_b32 v52, 16, v214
    v_and_b32 v53, 0xffff0000, v214
    v_lshlrev_b32 v54, 16, v215
    v_and_b32 v55, 0xffff0000, v215
    v_lshlrev_b32 v56, 16, v216
    v_and_b32 v57, 0xffff0000, v216
    v_pk_add_f32 v[30:31], v[48:49], v[50:51]
    v_pk_add_f32 v[32:33], v[52:53], v[54:55]
    v_pk_add_f32 v[30:31], v[30:31], v[56:57]
    v_pk_add_f32 v[30:31], v[30:31], v[32:33]
    v_add_f32 v30, v30, v31
    s_nop 1
    v_add_f32_dpp v30, v30, v30 row_ror:8 row_mask:0xf bank_mask:0xf
    s_nop 1
    v_add_f32_dpp v30, v30, v30 row_ror:4 row_mask:0xf bank_mask:0xf
    s_nop 1
    v_add_f32_dpp v30, v30, v30 row_ror:2 row_mask:0xf bank_mask:0xf
    s_nop 1
    v_add_f32_dpp v30, v30, v30 row_ror:1 row_mask:0xf bank_mask:0xf
    v_mov_b32 v31, v30
    s_nop 1
    v_permlane16_swap_b32 v30, v31
    v_add_f32 v30, v30, v31
    v_mov_b32 v31, v30
    s_nop 1
    v_permlane32_swap_b32 v30, v31
    v_add_f32 v30, v30, v31
    s_mov_b32 m0, s63
    s_add_u32 s63, s63, 1024
    buffer_load_dwordx4 v36, s[16:19], s62 offen  lds
    s_add_u32 s62, s62, s65
    s_mov_b32 m0, s63
    s_add_u32 s63, s63, 1024
    buffer_load_dwordx4 v37, s[16:19], s62 offen  lds
    s_add_u32 s62, s62, s65
    v_mul_f32 v30, 0xbacccccd, v30
    v_pk_add_f32 v[48:49], v[48:49], v[30:31] op_sel_hi:[1,0]
    v_pk_add_f32 v[50:51], v[50:51], v[30:31] op_sel_hi:[1,0]
    v_pk_add_f32 v[52:53], v[52:53], v[30:31] op_sel_hi:[1,0]
    v_pk_add_f32 v[54:55], v[54:55], v[30:31] op_sel_hi:[1,0]
    v_pk_add_f32 v[56:57], v[56:57], v[30:31] op_sel_hi:[1,0]
    v_pk_mul_f32 v[32:33], v[48:49], v[48:49]
    v_pk_fma_f32 v[32:33], v[50:51], v[50:51], v[32:33]
    v_pk_fma_f32 v[32:33], v[52:53], v[52:53], v[32:33]
    v_pk_fma_f32 v[32:33], v[54:55], v[54:55], v[32:33]
    v_pk_fma_f32 v[32:33], v[56:57], v[56:57], v[32:33]
    v_add_f32 v32, v32, v33
    s_nop 1
    v_add_f32_dpp v32, v32, v32 row_ror:8 row_mask:0xf bank_mask:0xf
    s_nop 1
    v_add_f32_dpp v32, v32, v32 row_ror:4 row_mask:0xf bank_mask:0xf
    s_nop 1
    v_add_f32_dpp v32, v32, v32 row_ror:2 row_mask:0xf bank_mask:0xf
    s_nop 1
    v_add_f32_dpp v32, v32, v32 row_ror:1 row_mask:0xf bank_mask:0xf
    v_mov_b32 v33, v32
    s_nop 1
    v_permlane16_swap_b32 v32, v33
    v_add_f32 v32, v32, v33
    v_mov_b32 v33, v32
    s_nop 1
    v_permlane32_swap_b32 v32, v33
    v_add_f32 v32, v32, v33
    s_mov_b32 m0, s63
    s_add_u32 s63, s63, 1024
    buffer_load_dwordx4 v38, s[16:19], s62 offen  lds
    s_add_u32 s62, s62, s65
    s_mov_b32 m0, s63
    s_add_u32 s63, s63, 1024
    buffer_load_dwordx4 v39, s[16:19], s62 offen  lds
    s_add_u32 s62, s62, s65
    s_cmp_ge_u32 s2, 128
    s_cselect_b32 s62, s56, s62
    s_cselect_b32 s63, s57, s63
    s_mov_b32 m0, s63
    s_add_u32 s63, s63, 1024
    buffer_load_dwordx4 v224, s[16:19], s62 offen  lds
    s_add_u32 s62, s62, s65
    v_mul_f32 v32, 0x3acccccd, v32
    v_cvt_pk_bf16_f32 v30, v30, v30
    v_and_b32 v30, 0xffff0000, v30
    v_cvt_pk_bf16_f32 v32, v32, v32
    v_and_b32 v32, 0xffff0000, v32
    v_add_f32 v32, 0x3727c5ac, v32
    v_cvt_pk_bf16_f32 v32, v32, v32
    v_and_b32 v32, 0xffff0000, v32
    v_sqrt_f32 v32, v32
    s_waitcnt lgkmcnt(0)
    v_lshlrev_b32 v48, 16, v40
    v_and_b32 v49, 0xffff0000, v40
    v_lshlrev_b32 v50, 16, v41
    v_and_b32 v51, 0xffff0000, v41
    v_lshlrev_b32 v52, 16, v42
    v_and_b32 v53, 0xffff0000, v42
    v_lshlrev_b32 v54, 16, v43
    v_and_b32 v55, 0xffff0000, v43
    v_lshlrev_b32 v56, 16, v44
    v_and_b32 v57, 0xffff0000, v44
    v_cvt_pk_bf16_f32 v32, v32, v32
    v_and_b32 v32, 0xffff0000, v32
    v_rcp_f32 v32, v32
    s_mov_b32 m0, s63
    s_add_u32 s63, s63, 1024
    buffer_load_dwordx4 v225, s[16:19], s62 offen  lds
    s_add_u32 s62, s62, s65
    s_mov_b32 m0, s63
    s_add_u32 s63, s63, 1024
    buffer_load_dwordx4 v226, s[16:19], s62 offen  lds
    s_add_u32 s62, s62, s65
    s_mov_b32 m0, s63
    s_add_u32 s63, s63, 1024
    buffer_load_dwordx4 v227, s[16:19], s62 offen  lds
    v_pk_add_f32 v[48:49], v[48:49], v[30:31] op_sel_hi:[1,0]
    v_pk_add_f32 v[50:51], v[50:51], v[30:31] op_sel_hi:[1,0]
    v_pk_add_f32 v[52:53], v[52:53], v[30:31] op_sel_hi:[1,0]
    v_pk_add_f32 v[54:55], v[54:55], v[30:31] op_sel_hi:[1,0]
    v_pk_add_f32 v[56:57], v[56:57], v[30:31] op_sel_hi:[1,0]
    v_cvt_pk_bf16_f32 v34, v48, v49
    v_lshlrev_b32 v48, 16, v34
    v_and_b32 v49, 0xffff0000, v34
    v_pk_mul_f32 v[48:49], v[48:49], v[32:33] op_sel_hi:[1,0]
    v_cvt_pk_bf16_f32 v20, v48, v48
    v_cvt_pk_bf16_f32 v21, v49, v49
    v_cvt_pk_bf16_f32 v34, v50, v51
    v_lshlrev_b32 v50, 16, v34
    v_and_b32 v51, 0xffff0000, v34
    v_pk_mul_f32 v[50:51], v[50:51], v[32:33] op_sel_hi:[1,0]
    v_cvt_pk_bf16_f32 v22, v50, v50
    v_cvt_pk_bf16_f32 v23, v51, v51
    v_cvt_pk_bf16_f32 v34, v52, v53
    v_lshlrev_b32 v52, 16, v34
    v_and_b32 v53, 0xffff0000, v34
    v_pk_mul_f32 v[52:53], v[52:53], v[32:33] op_sel_hi:[1,0]
    v_cvt_pk_bf16_f32 v24, v52, v52
    v_cvt_pk_bf16_f32 v25, v53, v53
    v_cvt_pk_bf16_f32 v34, v54, v55
    v_lshlrev_b32 v54, 16, v34
    v_and_b32 v55, 0xffff0000, v34
    v_pk_mul_f32 v[54:55], v[54:55], v[32:33] op_sel_hi:[1,0]
    v_cvt_pk_bf16_f32 v26, v54, v54
    v_cvt_pk_bf16_f32 v27, v55, v55
    v_cvt_pk_bf16_f32 v34, v56, v57
    v_lshlrev_b32 v56, 16, v34
    v_and_b32 v57, 0xffff0000, v34
    v_pk_mul_f32 v[56:57], v[56:57], v[32:33] op_sel_hi:[1,0]
    v_cvt_pk_bf16_f32 v28, v56, v56
    v_cvt_pk_bf16_f32 v29, v57, v57
    v_cndmask_b32 v52, v20, v25, s[30:31]
    v_cndmask_b32 v53, v21, v26, s[30:31]
    v_cndmask_b32 v54, v22, v27, s[30:31]
    v_cndmask_b32 v55, v23, v28, s[30:31]
    v_cndmask_b32 v56, v24, v29, s[30:31]
    v_and_b32 v40, v52, v4
    v_and_b32 v41, v52, v5
    v_and_b32 v42, v52, v6
    v_and_b32 v43, v52, v7
    v_and_b32 v44, v53, v4
    v_and_b32 v45, v53, v5
    v_and_b32 v46, v53, v6
    v_and_b32 v47, v53, v7
    s_waitcnt vmcnt(13)
    v_mfma_f32_16x16x32_bf16 v[48:51], v[40:43], v[64:67], 0
    v_and_b32 v40, v54, v4
    v_and_b32 v41, v54, v5
    v_and_b32 v42, v54, v6
    v_and_b32 v43, v54, v7
    s_waitcnt vmcnt(12)
    v_mfma_f32_16x16x32_bf16 v[48:51], v[44:47], v[68:71], v[48:51]
    v_and_b32 v44, v55, v4
    v_and_b32 v45, v55, v5
    v_and_b32 v46, v55, v6
    v_and_b32 v47, v55, v7
    s_waitcnt vmcnt(11)
    v_mfma_f32_16x16x32_bf16 v[48:51], v[40:43], v[72:75], v[48:51]
    v_and_b32 v40, v56, v4
    v_and_b32 v41, v56, v5
    v_and_b32 v42, v56, v6
    v_and_b32 v43, v56, v7
    s_waitcnt vmcnt(10)
    v_mfma_f32_16x16x32_bf16 v[48:51], v[44:47], v[76:79], v[48:51]
    s_waitcnt vmcnt(9)
    v_mfma_f32_16x16x32_bf16 v[48:51], v[40:43], v[80:83], v[48:51]
    s_add_u32 s40, s40, 0x9e3779b9
    s_lshl_b32 s59, s40, 2
    v_mov_b32 v211, s40
    s_nop 4
    ds_write_b128 v12, v[48:51]
    s_waitcnt lgkmcnt(0)
    s_barrier
    s_cmp_lg_u32 s3, 0
    s_cbranch_scc1 W0_1
    s_mov_b32 exec_hi, 0
    ds_read_b128 v[64:67], v13 offset:0
    ds_read_b128 v[68:71], v13 offset:512
    ds_read_b128 v[72:75], v13 offset:1024
    ds_read_b128 v[76:79], v13 offset:1536
    s_waitcnt lgkmcnt(0)
    v_pk_add_f32 v[64:65], v[64:65], v[68:69]
    v_pk_add_f32 v[66:67], v[66:67], v[70:71]
    v_pk_add_f32 v[72:73], v[72:73], v[76:77]
    v_pk_add_f32 v[74:75], v[74:75], v[78:79]
    v_pk_add_f32 v[60:61], v[64:65], v[72:73]
    v_pk_add_f32 v[62:63], v[66:67], v[74:75]
    v_bfi_b32 v60, v8, s40, v60
    v_bfi_b32 v61, v8, s40, v61
    v_bfi_b32 v62, v8, s40, v62
    v_bfi_b32 v63, v8, s40, v63
    buffer_store_dwordx4 v[60:63], v204, s[24:27], s54 offen
    s_mov_b32 exec_hi, -1
W0_1:
    s_cmp_ge_u32 s2, 128
    s_cbranch_scc1 L_Y
    s_load_dwordx2 s[32:33], s[0:1], 32
    s_mov_b32 s34, 0x400000
    s_mov_b32 s35, 0x20000
    s_load_dwordx2 s[12:13], s[0:1], 56
    s_mov_b32 s14, 0x21c000
    s_mov_b32 s15, 0x20000
    s_load_dwordx2 s[28:29], s[0:1], 64
    s_mov_b32 s30, 0x21c000
    s_mov_b32 s31, 0x20000
    s_load_dwordx2 s[36:37], s[0:1], 80
    s_mov_b32 s38, 0x500
    s_mov_b32 s39, 0x20000
    s_add_u32 s52, s56, 16384
    v_lshlrev_b32 v205, 3, v1
    s_lshl_b32 s6, s4, 12
    s_add_u32 s56, s6, 1703936
    s_add_u32 s57, s6, 1835008
    v_and_b32 v9, 7, v2
    v_lshlrev_b32 v9, 1, v9
    v_xor_b32 v9, v9, v3
    v_lshlrev_b32 v9, 4, v9
    v_lshl_add_u32 v9, v2, 9, v9
    s_lshl_b32 s7, s3, 13
    v_add_u32 v200, s7, v9
    v_xor_b32 v201, 64, v200
    v_xor_b32 v202, 128, v200
    v_xor_b32 v203, 192, v200
    s_lshl_b32 s7, s3, 8
    v_lshl_add_u32 v206, v1, 2, s7
    v_lshl_add_u32 v207, v3, 4, s7
    s_lshl_b32 s7, s3, 6
    v_lshl_add_u32 v208, v2, 2, s7
    v_lshlrev_b32 v209, 2, v1
    v_lshlrev_b32 v210, 12, v1
    s_lshl_b32 s6, s4, 2
    s_add_u32 s58, s6, s5
    s_lshl_b32 s6, s58, 8
    s_add_u32 s60, s6, 98304
    s_lshl_b32 s6, s58, 6
    s_add_u32 s61, s6, 131072
    s_lshl_b32 s6, s4, 7
    s_add_u32 s64, s6, 4096
    v_lshrrev_b32 v12, 3, v2
    v_and_b32 v13, 7, v2
    v_lshl_add_u32 v9, v3, 1, v12
    v_mul_u32_u24 v9, 17280, v9
    v_lshl_add_u32 v16, v13, 4, v9
    s_mul_i32 s6, s51, 3456
    s_lshl_b32 s7, s4, 7
    s_add_u32 s48, s6, s7
    s_lshl_b32 s6, s5, 7
    s_lshl_b32 s7, s3, 2
    s_add_u32 s6, s6, s7
    s_lshl_b32 s6, s6, 13
    s_add_u32 s49, s6, s53
    v_and_b32 v9, 1, v3
    v_lshlrev_b32 v9, 3, v9
    v_xor_b32 v9, v9, v2
    v_lshlrev_b32 v9, 4, v9
    v_lshl_add_u32 v36, v3, 13, v9
    v_xor_b32 v37, 32, v36
    v_xor_b32 v38, 64, v36
    v_xor_b32 v39, 96, v36
    s_lshl_b32 s63, s3, 13
    s_add_u32 s63, s63, 65536
    s_lshl_b32 s6, s4, 11
    s_lshl_b32 s7, s5, 9
    s_add_u32 s7, s7, s6
    s_add_u32 s65, s7, 327680
    s_add_u32 s67, s7, 393216
    v_cmp_eq_u32 vcc, 1, v12
    v_lshrrev_b32 v9, 1, v3
    v_and_b32 v10, 1, v3
    v_cndmask_b32 v20, v20, v25, vcc
    v_cndmask_b32 v21, v21, v26, vcc
    v_cndmask_b32 v22, v22, v27, vcc
    v_cndmask_b32 v23, v23, v28, vcc
    v_cndmask_b32 v24, v24, v29, vcc
    v_cmp_eq_u32 vcc, v9, v12
    v_lshlrev_b32 v9, 5, v13
    v_lshl_add_u32 v9, v10, 4, v9
    v_lshl_add_u32 v9, v12, 9, v9
    s_lshl_b32 s7, s3, 10
    v_add_u32 v9, s7, v9
    v_add_u32 v11, 4096, v204
    v_cndmask_b32 v19, v11, v9, vcc
    v_lshlrev_b32 v18, 9, v2
    s_lshr_b32 s6, s4, 4
    s_lshl_b32 s6, s6, 15
    s_and_b32 s7, s4, 15
    s_lshl_b32 s7, s7, 5
    s_add_u32 s6, s6, s7
    s_lshl_b32 s7, s3, 13
    s_add_u32 s6, s6, s7
    s_add_u32 s66, s6, 983040
    v_lshlrev_b32 v17, 7, v1
    s_lshr_b32 s6, s2, 3
    s_lshl_b32 s6, s6, 2
    s_add_u32 s6, s6, s3
    s_lshl_b32 s6, s6, 8
    s_add_u32 s42, s6, 69632
    s_and_b32 s7, s2, 7
    s_lshl_b32 s7, s7, 14
    s_add_u32 s7, s7, s6
    s_add_u32 s43, s7, 196608
    s_cmp_ge_u32 s4, 27
    s_cselect_b32 s48, 0x7000000, s48
    s_waitcnt vmcnt(1) lgkmcnt(0)
    s_cmp_eq_u32 s3, 0
    s_cbranch_scc1 X_UKW
    s_waitcnt vmcnt(0)
X_UKW:
    ds_read_b128 v[128:131], v200 offset:0
    ds_read_b128 v[132:135], v201 offset:0
    ds_read_b128 v[136:139], v202 offset:0
    ds_read_b128 v[140:143], v203 offset:0
    ds_read_b128 v[144:147], v200 offset:256
    ds_read_b128 v[148:151], v201 offset:256
    ds_read_b128 v[152:155], v202 offset:256
    ds_read_b128 v[156:159], v203 offset:256
    s_mov_b32 s50, 12
PA_2:
    buffer_load_dwordx2 v[64:65], v205, s[24:27], s56 offen offset:0 sc1
    buffer_load_dwordx2 v[66:67], v205, s[24:27], s56 offen offset:512 sc1
    buffer_load_dwordx2 v[68:69], v205, s[24:27], s56 offen offset:1024 sc1
    buffer_load_dwordx2 v[70:71], v205, s[24:27], s56 offen offset:1536 sc1
    buffer_load_dwordx2 v[72:73], v205, s[24:27], s56 offen offset:2048 sc1
    buffer_load_dwordx2 v[74:75], v205, s[24:27], s56 offen offset:2560 sc1
    buffer_load_dwordx2 v[76:77], v205, s[24:27], s56 offen offset:3072 sc1
    buffer_load_dwordx2 v[78:79], v205, s[24:27], s56 offen offset:3584 sc1
    s_sub_u32 s41, s41, 1
    s_cmp_lt_i32 s41, 0
    s_cbranch_scc1 PD_3
    s_waitcnt vmcnt(0)
    v_xor_b32 v9, s40, v64
    v_bitop3_b32 v9, v9, v65, s40 bitop3:0xf6
    v_bitop3_b32 v9, v9, v66, s40 bitop3:0xf6
    v_bitop3_b32 v9, v9, v67, s40 bitop3:0xf6
    v_bitop3_b32 v9, v9, v68, s40 bitop3:0xf6
    v_bitop3_b32 v9, v9, v69, s40 bitop3:0xf6
    v_bitop3_b32 v9, v9, v70, s40 bitop3:0xf6
    v_bitop3_b32 v9, v9, v71, s40 bitop3:0xf6
    v_bitop3_b32 v9, v9, v72, s40 bitop3:0xf6
    v_bitop3_b32 v9, v9, v73, s40 bitop3:0xf6
    v_bitop3_b32 v9, v9, v74, s40 bitop3:0xf6
    v_bitop3_b32 v9, v9, v75, s40 bitop3:0xf6
    v_bitop3_b32 v9, v9, v76, s40 bitop3:0xf6
    v_bitop3_b32 v9, v9, v77, s40 bitop3:0xf6
    v_bitop3_b32 v9, v9, v78, s40 bitop3:0xf6
    v_bitop3_b32 v9, v9, v79, s40 bitop3:0xf6
    v_and_b32 v9, v8, v9
    v_cmp_ne_u32 vcc, 0, v9
    s_cbranch_vccz PD_3
    s_sub_u32 s50, s50, 1
    s_cbranch_scc0 PA_2
    s_cmp_lg_u32 s3, 0
    s_cbranch_scc1 W0_4
    s_mov_b32 exec_hi, 0
    buffer_store_dwordx4 v[60:63], v204, s[24:27], s55 offen sc1
    s_mov_b32 exec_hi, -1
W0_4:
    s_mov_b32 s50, 12
    buffer_load_dwordx2 v[64:65], v205, s[24:27], s57 offen offset:0 sc1
    buffer_load_dwordx2 v[66:67], v205, s[24:27], s57 offen offset:512 sc1
    buffer_load_dwordx2 v[68:69], v205, s[24:27], s57 offen offset:1024 sc1
    buffer_load_dwordx2 v[70:71], v205, s[24:27], s57 offen offset:1536 sc1
    buffer_load_dwordx2 v[72:73], v205, s[24:27], s57 offen offset:2048 sc1
    buffer_load_dwordx2 v[74:75], v205, s[24:27], s57 offen offset:2560 sc1
    buffer_load_dwordx2 v[76:77], v205, s[24:27], s57 offen offset:3072 sc1
    buffer_load_dwordx2 v[78:79], v205, s[24:27], s57 offen offset:3584 sc1
    s_waitcnt vmcnt(0)
    v_xor_b32 v9, s40, v64
    v_bitop3_b32 v9, v9, v65, s40 bitop3:0xf6
    v_bitop3_b32 v9, v9, v66, s40 bitop3:0xf6
    v_bitop3_b32 v9, v9, v67, s40 bitop3:0xf6
    v_bitop3_b32 v9, v9, v68, s40 bitop3:0xf6
    v_bitop3_b32 v9, v9, v69, s40 bitop3:0xf6
    v_bitop3_b32 v9, v9, v70, s40 bitop3:0xf6
    v_bitop3_b32 v9, v9, v71, s40 bitop3:0xf6
    v_bitop3_b32 v9, v9, v72, s40 bitop3:0xf6
    v_bitop3_b32 v9, v9, v73, s40 bitop3:0xf6
    v_bitop3_b32 v9, v9, v74, s40 bitop3:0xf6
    v_bitop3_b32 v9, v9, v75, s40 bitop3:0xf6
    v_bitop3_b32 v9, v9, v76, s40 bitop3:0xf6
    v_bitop3_b32 v9, v9, v77, s40 bitop3:0xf6
    v_bitop3_b32 v9, v9, v78, s40 bitop3:0xf6
    v_bitop3_b32 v9, v9, v79, s40 bitop3:0xf6
    v_and_b32 v9, v8, v9
    v_cmp_ne_u32 vcc, 0, v9
    s_cbranch_vccnz PA_2
PD_3:
    v_pk_add_f32 v[64:65], v[64:65], v[66:67]
    v_pk_add_f32 v[68:69], v[68:69], v[70:71]
    v_pk_add_f32 v[72:73], v[72:73], v[74:75]
    v_pk_add_f32 v[76:77], v[76:77], v[78:79]
    v_pk_add_f32 v[64:65], v[64:65], v[68:69]
    v_pk_add_f32 v[72:73], v[72:73], v[76:77]
    v_pk_add_f32 v[64:65], v[64:65], v[72:73]
    v_cvt_pk_bf16_f32 v64, v64, v65
    ds_write_b32 v206, v64 offset:32768
    buffer_load_dwordx4 v[160:163], v16, s[12:15], s48 offen
    buffer_load_dwordx4 v[164:167], v16, s[28:31], s48 offen
    s_add_u32 s48, s48, 3456
    s_waitcnt lgkmcnt(0)
    ds_read_b128 v[64:67], v207 offset:32768
    ds_read_b128 v[68:71], v207 offset:32832
    ds_read_b128 v[72:75], v207 offset:32896
    ds_read_b128 v[76:79], v207 offset:32960
    s_waitcnt lgkmcnt(3)
    v_mfma_f32_16x16x32_bf16 v[48:51], v[64:67], v[128:131], 0
    v_mfma_f32_16x16x32_bf16 v[52:55], v[64:67], v[144:147], 0
    s_waitcnt lgkmcnt(2)
    v_mfma_f32_16x16x32_bf16 v[48:51], v[68:71], v[132:135], v[48:51]
    v_mfma_f32_16x16x32_bf16 v[52:55], v[68:71], v[148:151], v[52:55]
    s_waitcnt lgkmcnt(1)
    v_mfma_f32_16x16x32_bf16 v[48:51], v[72:75], v[136:139], v[48:51]
    v_mfma_f32_16x16x32_bf16 v[52:55], v[72:75], v[152:155], v[52:55]
    s_waitcnt lgkmcnt(0)
    v_mfma_f32_16x16x32_bf16 v[48:51], v[76:79], v[140:143], v[48:51]
    v_mfma_f32_16x16x32_bf16 v[52:55], v[76:79], v[156:159], v[52:55]
    s_nop 7
    v_cvt_pk_bf16_f32 v56, v48, v52
    ds_write_b32 v208, v56 offset:33792
    s_or_b32 s7, s3, s5
    s_cbranch_scc1 QF_5
    s_mov_b64 exec, 0xff
    buffer_store_dword v211, v210, s[24:27], s64 offen sc1
    s_mov_b64 exec, -1
QF_5:
    s_waitcnt lgkmcnt(0)
    s_barrier
    s_cmp_lg_u32 s3, 0
    s_cbranch_scc1 W0_6
    s_mov_b64 exec, 0xffff
    ds_read_b128 v[64:67], v204 offset:33792
    s_waitcnt lgkmcnt(0)
    buffer_store_dwordx4 v[64:67], v204, s[24:27], s60 offen sc1
    v_add3_u32 v68, v64, v65, s40
    v_add3_u32 v68, v66, v67, v68
    buffer_store_dword v68, v209, s[24:27], s61 offen sc1
    s_mov_b64 exec, -1
W0_6:
    s_cmp_lg_u32 s3, 0
    s_cbranch_scc1 W0_7
    s_mov_b32 exec_hi, 0
    buffer_store_dwordx4 v[60:63], v204, s[24:27], s55 offen sc1
    s_mov_b32 exec_hi, -1
W0_7:
    s_cmp_ge_u32 s4, 27
    s_cbranch_scc1 X_NOG
    buffer_load_dwordx4 v[168:171], v16, s[12:15], s48 offen
    buffer_load_dwordx4 v[172:175], v16, s[28:31], s48 offen
    s_add_u32 s48, s48, 3456
    buffer_load_dwordx4 v[176:179], v16, s[12:15], s48 offen
    buffer_load_dwordx4 v[180:183], v16, s[28:31], s48 offen
    s_add_u32 s48, s48, 3456
    buffer_load_dwordx4 v[184:187], v16, s[12:15], s48 offen
    buffer_load_dwordx4 v[188:191], v16, s[28:31], s48 offen
    s_add_u32 s48, s48, 3456
    buffer_load_dwordx4 v[192:195], v16, s[12:15], s48 offen
    buffer_load_dwordx4 v[196:199], v16, s[28:31], s48 offen
    s_mov_b32 m0, s63
    s_add_u32 s63, s63, 1024
    buffer_load_dwordx4 v36, s[32:35], s49 offen  lds
    s_add_u32 s49, s49, 131072
    s_mov_b32 m0, s63
    s_add_u32 s63, s63, 1024
    buffer_load_dwordx4 v37, s[32:35], s49 offen  lds
    s_add_u32 s49, s49, 131072
    s_mov_b32 m0, s63
    s_add_u32 s63, s63, 1024
    buffer_load_dwordx4 v38, s[32:35], s49 offen  lds
    s_add_u32 s49, s49, 131072
    s_mov_b32 m0, s63
    s_add_u32 s63, s63, 1024
    buffer_load_dwordx4 v39, s[32:35], s49 offen  lds
    s_add_u32 s49, s49, 131072
    s_mov_b32 m0, s63
    s_add_u32 s63, s63, 1024
    buffer_load_dwordx4 v36, s[32:35], s49 offen  lds
    s_add_u32 s49, s49, 131072
    s_mov_b32 m0, s63
    s_add_u32 s63, s63, 1024
    buffer_load_dwordx4 v37, s[32:35], s49 offen  lds
    s_add_u32 s49, s49, 131072
    s_mov_b32 m0, s63
    s_add_u32 s63, s63, 1024
    buffer_load_dwordx4 v38, s[32:35], s49 offen  lds
    s_add_u32 s49, s49, 131072
    s_mov_b32 m0, s63
    s_add_u32 s63, s63, 1024
    buffer_load_dwordx4 v39, s[32:35], s49 offen  lds
    s_mov_b64 exec, 0xffff
    buffer_load_dword v32, v18, s[24:27], s66 offen sc1
    s_mov_b64 exec, 3
    buffer_load_dword v32, v17, s[24:27], s42 offen sc1
    buffer_load_dword v32, v17, s[24:27], s43 offen sc1
    s_mov_b64 exec, -1
    v_and_b32 v40, v20, v4
    v_and_b32 v41, v20, v5
    v_and_b32 v42, v20, v6
    v_and_b32 v43, v20, v7
    s_waitcnt vmcnt(19)
    s_nop 0
    v_mfma_f32_16x16x32_bf16 v[48:51], v[40:43], v[160:163], 0
    v_mfma_f32_16x16x32_bf16 v[52:55], v[40:43], v[164:167], 0
    v_and_b32 v44, v21, v4
    v_and_b32 v45, v21, v5
    v_and_b32 v46, v21, v6
    v_and_b32 v47, v21, v7
    s_waitcnt vmcnt(17)
    s_nop 0
    v_mfma_f32_16x16x32_bf16 v[48:51], v[44:47], v[168:171], v[48:51]
    v_mfma_f32_16x16x32_bf16 v[52:55], v[44:47], v[172:175], v[52:55]
    v_and_b32 v40, v22, v4
    v_and_b32 v41, v22, v5
    v_and_b32 v42, v22, v6
    v_and_b32 v43, v22, v7
    s_waitcnt vmcnt(15)
    s_nop 0
    v_mfma_f32_16x16x32_bf16 v[48:51], v[40:43], v[176:179], v[48:51]
    v_mfma_f32_16x16x32_bf16 v[52:55], v[40:43], v[180:183], v[52:55]
    v_and_b32 v44, v23, v4
    v_and_b32 v45, v23, v5
    v_and_b32 v46, v23, v6
    v_and_b32 v47, v23, v7
    s_waitcnt vmcnt(13)
    s_nop 0
    v_mfma_f32_16x16x32_bf16 v[48:51], v[44:47], v[184:187], v[48:51]
    v_mfma_f32_16x16x32_bf16 v[52:55], v[44:47], v[188:191], v[52:55]
    v_and_b32 v40, v24, v4
    v_and_b32 v41, v24, v5
    v_and_b32 v42, v24, v6
    v_and_b32 v43, v24, v7
    s_waitcnt vmcnt(11)
    s_nop 0
    v_mfma_f32_16x16x32_bf16 v[48:51], v[40:43], v[192:195], v[48:51]
    v_mfma_f32_16x16x32_bf16 v[52:55], v[40:43], v[196:199], v[52:55]
    s_nop 7
    ds_write_b128 v19, v[48:51] offset:36416
    ds_write_b128 v19, v[52:55] offset:36672
    s_waitcnt lgkmcnt(0)
    s_barrier
    s_cmp_lg_u32 s3, 0
    s_cbranch_scc1 W0_10
    s_mov_b32 exec_hi, 0
    ds_read_b128 v[64:67], v204 offset:36416
    ds_read_b128 v[68:71], v204 offset:36928
    ds_read_b128 v[72:75], v204 offset:37440
    ds_read_b128 v[76:79], v204 offset:37952
    ds_read_b128 v[80:83], v204 offset:38464
    ds_read_b128 v[84:87], v204 offset:38976
    ds_read_b128 v[88:91], v204 offset:39488
    ds_read_b128 v[92:95], v204 offset:40000
    s_waitcnt lgkmcnt(0)
    v_pk_add_f32 v[64:65], v[64:65], v[68:69]
    v_pk_add_f32 v[66:67], v[66:67], v[70:71]
    v_pk_add_f32 v[72:73], v[72:73], v[76:77]
    v_pk_add_f32 v[74:75], v[74:75], v[78:79]
    v_pk_add_f32 v[64:65], v[64:65], v[72:73]
    v_pk_add_f32 v[66:67], v[66:67], v[74:75]
    v_pk_add_f32 v[80:81], v[80:81], v[84:85]
    v_pk_add_f32 v[82:83], v[82:83], v[86:87]
    v_pk_add_f32 v[88:89], v[88:89], v[92:93]
    v_pk_add_f32 v[90:91], v[90:91], v[94:95]
    v_pk_add_f32 v[80:81], v[80:81], v[88:89]
    v_pk_add_f32 v[82:83], v[82:83], v[90:91]
    v_pk_add_f32 v[64:65], v[64:65], v[80:81]
    v_pk_add_f32 v[66:67], v[66:67], v[82:83]
    v_bfi_b32 v64, v8, s40, v64
    v_bfi_b32 v65, v8, s40, v65
    v_bfi_b32 v66, v8, s40, v66
    v_bfi_b32 v67, v8, s40, v67
    buffer_store_dwordx4 v[64:67], v204, s[24:27], s65 offen
    buffer_store_dwordx4 v[64:67], v204, s[24:27], s67 offen sc1
    s_mov_b32 exec_hi, -1
W0_10:
    s_branch X_LD
X_NOG:
    s_mov_b32 m0, s63
    s_add_u32 s63, s63, 1024
    buffer_load_dwordx4 v36, s[32:35], s49 offen  lds
    s_add_u32 s49, s49, 131072
    s_mov_b32 m0, s63
    s_add_u32 s63, s63, 1024
    buffer_load_dwordx4 v37, s[32:35], s49 offen  lds
    s_add_u32 s49, s49, 131072
    s_mov_b32 m0, s63
    s_add_u32 s63, s63, 1024
    buffer_load_dwordx4 v38, s[32:35], s49 offen  lds
    s_add_u32 s49, s49, 131072
    s_mov_b32 m0, s63
    s_add_u32 s63, s63, 1024
    buffer_load_dwordx4 v39, s[32:35], s49 offen  lds
    s_add_u32 s49, s49, 131072
    s_mov_b32 m0, s63
    s_add_u32 s63, s63, 1024
    buffer_load_dwordx4 v36, s[32:35], s49 offen  lds
    s_add_u32 s49, s49, 131072
    s_mov_b32 m0, s63
    s_add_u32 s63, s63, 1024
    buffer_load_dwordx4 v37, s[32:35], s49 offen  lds
    s_add_u32 s49, s49, 131072
    s_mov_b32 m0, s63
    s_add_u32 s63, s63, 1024
    buffer_load_dwordx4 v38, s[32:35], s49 offen  lds
    s_add_u32 s49, s49, 131072
    s_mov_b32 m0, s63
    s_add_u32 s63, s63, 1024
    buffer_load_dwordx4 v39, s[32:35], s49 offen  lds
    s_mov_b64 exec, 0xffff
    buffer_load_dword v32, v18, s[24:27], s66 offen sc1
    s_mov_b64 exec, 3
    buffer_load_dword v32, v17, s[24:27], s42 offen sc1
    buffer_load_dword v32, v17, s[24:27], s43 offen sc1
    s_mov_b64 exec, -1
X_LD:
    v_lshlrev_b32 v10, 10, v3
    v_lshl_add_u32 v10, v2, 4, v10
    v_lshlrev_b32 v11, 8, v3
    v_lshl_add_u32 v11, v2, 2, v11
    s_lshl_b32 s6, s58, 2
    s_add_u32 s6, s6, s3
    s_lshl_b32 s7, s6, 12
    s_add_u32 s55, s7, 2097152
    s_lshl_b32 s7, s6, 10
    s_add_u32 s56, s7, 4194304
    s_lshl_b32 s7, s3, 6
    v_lshl_add_u32 v12, v2, 2, s7
    v_lshl_add_u32 v13, v3, 4, s7
    s_lshl_b32 s7, s3, 2
    v_mov_b32 v16, s7
    v_mov_b32 v19, 0
    s_lshl_b32 s7, s3, 7
    v_lshl_add_u32 v20, v3, 5, s7
    s_lshl_b32 s7, s6, 9
    s_add_u32 s60, s7, 458752
    s_add_u32 s61, s7, 720896
    v_bfe_u32 v9, v1, 2, 2
    v_and_b32 v21, 1, v3
    v_lshl_add_u32 v21, v21, 2, v9
    v_lshlrev_b32 v21, 5, v21
    v_lshl_add_u32 v21, v9, 10, v21
    v_lshl_add_u32 v21, v3, 8, v21
    v_and_b32 v9, 3, v1
    v_lshl_add_u32 v21, v9, 3, v21
    s_lshl_b32 s7, s3, 13
    s_add_u32 s7, s7, 65536
    v_add_u32 v220, s7, v21
    v_xor_b32 v221, 32, v220
    v_xor_b32 v222, 64, v220
    v_xor_b32 v223, 96, v220
    v_xor_b32 v224, 128, v220
    v_xor_b32 v225, 160, v220
    v_xor_b32 v226, 192, v220
    v_xor_b32 v227, 224, v220
    s_mov_b32 s42, 0xffff0000
    s_mov_b32 s43, 0
    s_mov_b32 s44, 0
    s_mov_b32 s45, 0xffff
    s_mov_b32 s46, 0
    s_mov_b32 s47, 0xffff0000
    v_lshlrev_b32 v228, 1, v0
    s_lshl_b32 s12, s2, 5
    buffer_load_ushort v235, v228, s[8:11], s12 offen
    v_and_b32 v9, 3, v0
    v_lshrrev_b32 v21, 2, v0
    v_lshlrev_b32 v233, 4, v9
    v_mul_u32_u24 v229, 2560, v21
    v_add_u32 v229, v229, v233
    v_add_u32 v230, 64, v21
    v_min_u32 v230, 107, v230
    v_mul_u32_u24 v230, 2560, v230
    v_add_u32 v230, v230, v233
    v_cmp_gt_u32 s[18:19], 44, v21
    s_lshl_b32 s7, s3, 4
    v_lshl_add_u32 v231, v3, 6, v2
    v_add_u32 v231, s7, v231
    v_min_u32 v232, 107, v231
    v_lshlrev_b32 v232, 7, v232
    v_lshrrev_b32 v231, 2, v1
    v_lshl_add_u32 v231, v231, 4, v9
    s_lshl_b32 s7, s3, 2
    v_add_u32 v231, s7, v231
    v_lshlrev_b32 v231, 9, v231
    s_and_b32 s6, s2, 7
    s_lshl_b32 s6, s6, 14
    s_add_u32 s13, s6, 196608
    s_lshl_b32 s6, s2, 6
    s_add_u32 s14, s6, 1048576
    s_add_u32 s15, s6, 1376256
    s_add_u32 s16, s15, 163840
    s_mov_b32 s17, 69632
    v_and_b32 v9, 1, v3
    v_lshlrev_b32 v9, 3, v9
    v_lshrrev_b32 v21, 1, v3
    v_lshl_add_u32 v9, v21, 2, v9
    v_add_u32 v233, v233, v9
    s_lshl_b32 s7, s3, 6
    v_add_u32 v233, s7, v233
    v_lshlrev_b32 v234, 2, v0
    s_mov_b64 exec, 0xffff
X_RP:
    buffer_load_dwordx4 v[32:35], v18, s[24:27], s66 offen sc1
    s_sub_u32 s41, s41, 1
    s_cmp_lt_i32 s41, 0
    s_cbranch_scc1 X_RD
    s_waitcnt vmcnt(0)
    v_cmp_ne_u32 vcc, s40, v34
    s_cbranch_vccnz X_RP
X_RD:
    s_mov_b64 exec, -1
    s_mov_b64 exec, 0xffff
    v_mov_b32 v36, v32
    s_nop 1
    v_max_f32_dpp v36, v36, v36 row_ror:8 row_mask:0xf bank_mask:0xf
    s_nop 1
    v_max_f32_dpp v36, v36, v36 row_ror:4 row_mask:0xf bank_mask:0xf
    s_nop 1
    v_max_f32_dpp v36, v36, v36 row_ror:2 row_mask:0xf bank_mask:0xf
    s_nop 1
    v_max_f32_dpp v36, v36, v36 row_ror:1 row_mask:0xf bank_mask:0xf
    v_sub_f32 v32, v32, v36
    v_exp_f32 v32, v32
    ds_write_b32 v16, v36 offset:34304
    v_mul_f32 v37, v32, v33
    v_cvt_pk_bf16_f32 v32, v32, v32
    ds_write_b32 v12, v32 offset:34048
    s_nop 1
    v_add_f32_dpp v37, v37, v37 row_ror:8 row_mask:0xf bank_mask:0xf
    s_nop 1
    v_add_f32_dpp v37, v37, v37 row_ror:4 row_mask:0xf bank_mask:0xf
    s_nop 1
    v_add_f32_dpp v37, v37, v37 row_ror:2 row_mask:0xf bank_mask:0xf
    s_nop 1
    v_add_f32_dpp v37, v37, v37 row_ror:1 row_mask:0xf bank_mask:0xf
    ds_write_b32 v16, v37 offset:34320
    s_mov_b64 exec, -1
    s_waitcnt lgkmcnt(0)
    ds_read_b128 v[32:35], v13 offset:34048
    s_barrier
    ds_read_b128 v[40:43], v19 offset:34304
    ds_read_b128 v[44:47], v19 offset:34320
    buffer_load_dwordx4 v[64:67], v10, s[24:27], s55 offen offset:0 sc1
    buffer_load_dwordx4 v[68:71], v10, s[24:27], s55 offen offset:256 sc1
    buffer_load_dwordx4 v[72:75], v10, s[24:27], s55 offen offset:512 sc1
    buffer_load_dwordx4 v[76:79], v10, s[24:27], s55 offen offset:768 sc1
    buffer_load_dword v80, v11, s[24:27], s56 offen offset:0 sc1
    buffer_load_dword v81, v11, s[24:27], s56 offen offset:64 sc1
    buffer_load_dword v82, v11, s[24:27], s56 offen offset:128 sc1
    buffer_load_dword v83, v11, s[24:27], s56 offen offset:192 sc1
    s_waitcnt lgkmcnt(2)
    v_and_b32 v96, v32, v4
    v_and_b32 v97, v32, v5
    v_and_b32 v98, v32, v6
    v_and_b32 v99, v32, v7
    v_and_b32 v100, v33, v4
    v_and_b32 v101, v33, v5
    v_and_b32 v102, v33, v6
    v_and_b32 v103, v33, v7
    v_and_b32 v104, v34, v4
    v_and_b32 v105, v34, v5
    v_and_b32 v106, v34, v6
    v_and_b32 v107, v34, v7
    v_and_b32 v108, v35, v4
    v_and_b32 v109, v35, v5
    v_and_b32 v110, v35, v6
    v_and_b32 v111, v35, v7
    s_waitcnt lgkmcnt(0)
    ds_read_b64_tr_b16 v[128:129], v220 offset:0
    ds_read_b64_tr_b16 v[130:131], v220 offset:4096
    ds_read_b64_tr_b16 v[132:133], v221 offset:0
    ds_read_b64_tr_b16 v[134:135], v221 offset:4096
    ds_read_b64_tr_b16 v[136:137], v222 offset:0
    ds_read_b64_tr_b16 v[138:139], v222 offset:4096
    ds_read_b64_tr_b16 v[140:141], v223 offset:0
    ds_read_b64_tr_b16 v[142:143], v223 offset:4096
    ds_read_b64_tr_b16 v[144:145], v224 offset:0
    ds_read_b64_tr_b16 v[146:147], v224 offset:4096
    ds_read_b64_tr_b16 v[148:149], v225 offset:0
    ds_read_b64_tr_b16 v[150:151], v225 offset:4096
    ds_read_b64_tr_b16 v[152:153], v226 offset:0
    ds_read_b64_tr_b16 v[154:155], v226 offset:4096
    ds_read_b64_tr_b16 v[156:157], v227 offset:0
    ds_read_b64_tr_b16 v[158:159], v227 offset:4096
    v_max3_f32 v36, v40, v41, v42
    v_max_f32 v36, v36, v43
    v_sub_f32 v40, v40, v36
    v_sub_f32 v41, v41, v36
    v_sub_f32 v42, v42, v36
    v_sub_f32 v43, v43, v36
    v_exp_f32 v40, v40
    v_exp_f32 v41, v41
    v_exp_f32 v42, v42
    v_exp_f32 v43, v43
    s_nop 0
    v_pk_mul_f32 v[44:45], v[44:45], v[40:41]
    v_pk_mul_f32 v[46:47], v[46:47], v[42:43]
    v_pk_add_f32 v[44:45], v[44:45], v[46:47]
    v_add_f32 v36, v44, v45
    v_rcp_f32 v36, v36
    s_nop 0
    v_pk_mul_f32 v[24:25], v[40:41], v[36:37] op_sel_hi:[1,0]
    v_pk_mul_f32 v[26:27], v[42:43], v[36:37] op_sel_hi:[1,0]
X_OP:
    s_waitcnt vmcnt(0)
    v_mfma_f32_16x16x32_bf16 v[48:51], v[96:99], v[64:67], 0
    v_mfma_f32_16x16x32_bf16 v[48:51], v[100:103], v[68:71], v[48:51]
    v_mfma_f32_16x16x32_bf16 v[48:51], v[104:107], v[72:75], v[48:51]
    v_mfma_f32_16x16x32_bf16 v[48:51], v[108:111], v[76:79], v[48:51]
    v_add3_u32 v38, v64, v65, s59
    v_add3_u32 v39, v80, v81, v82
    v_add3_u32 v38, v66, v67, v38
    v_add3_u32 v38, v68, v69, v38
    v_add3_u32 v38, v70, v71, v38
    v_add3_u32 v38, v72, v73, v38
    v_add3_u32 v38, v74, v75, v38
    v_add3_u32 v38, v76, v77, v38
    v_add3_u32 v38, v78, v79, v38
    v_add_u32 v39, v39, v83
    v_cmp_ne_u32 vcc, v38, v39
    s_cbranch_vccz X_OD
    s_sub_u32 s41, s41, 1
    s_cmp_lt_i32 s41, 0
    s_cbranch_scc1 X_OD
    buffer_load_dwordx4 v[64:67], v10, s[24:27], s55 offen offset:0 sc1
    buffer_load_dwordx4 v[68:71], v10, s[24:27], s55 offen offset:256 sc1
    buffer_load_dwordx4 v[72:75], v10, s[24:27], s55 offen offset:512 sc1
    buffer_load_dwordx4 v[76:79], v10, s[24:27], s55 offen offset:768 sc1
    buffer_load_dword v80, v11, s[24:27], s56 offen offset:0 sc1
    buffer_load_dword v81, v11, s[24:27], s56 offen offset:64 sc1
    buffer_load_dword v82, v11, s[24:27], s56 offen offset:128 sc1
    buffer_load_dword v83, v11, s[24:27], s56 offen offset:192 sc1
    s_branch X_OP
X_OD:
    ds_write_b128 v15, v[48:51] offset:34368
    s_waitcnt lgkmcnt(0)
    s_barrier
    ds_read_b128 v[64:67], v20 offset:34368
    ds_read_b128 v[68:71], v20 offset:34384
    ds_read_b128 v[72:75], v20 offset:34880
    ds_read_b128 v[76:79], v20 offset:34896
    ds_read_b128 v[80:83], v20 offset:35392
    ds_read_b128 v[84:87], v20 offset:35408
    ds_read_b128 v[88:91], v20 offset:35904
    ds_read_b128 v[92:95], v20 offset:35920
    s_waitcnt lgkmcnt(6)
    v_pk_mul_f32 v[64:65], v[64:65], v[24:25] op_sel_hi:[1,0]
    v_pk_mul_f32 v[66:67], v[66:67], v[24:25] op_sel_hi:[1,0]
    v_pk_mul_f32 v[68:69], v[68:69], v[24:25] op_sel_hi:[1,0]
    v_pk_mul_f32 v[70:71], v[70:71], v[24:25] op_sel_hi:[1,0]
    s_waitcnt lgkmcnt(4)
    v_pk_fma_f32 v[64:65], v[72:73], v[24:25], v[64:65] op_sel:[0,1,0]
    v_pk_fma_f32 v[66:67], v[74:75], v[24:25], v[66:67] op_sel:[0,1,0]
    v_pk_fma_f32 v[68:69], v[76:77], v[24:25], v[68:69] op_sel:[0,1,0]
    v_pk_fma_f32 v[70:71], v[78:79], v[24:25], v[70:71] op_sel:[0,1,0]
    s_waitcnt lgkmcnt(2)
    v_pk_fma_f32 v[64:65], v[80:81], v[26:27], v[64:65] op_sel_hi:[1,0,1]
    v_pk_fma_f32 v[66:67], v[82:83], v[26:27], v[66:67] op_sel_hi:[1,0,1]
    v_pk_fma_f32 v[68:69], v[84:85], v[26:27], v[68:69] op_sel_hi:[1,0,1]
    v_pk_fma_f32 v[70:71], v[86:87], v[26:27], v[70:71] op_sel_hi:[1,0,1]
    s_waitcnt lgkmcnt(0)
    v_pk_fma_f32 v[64:65], v[88:89], v[26:27], v[64:65] op_sel:[0,1,0]
    v_pk_fma_f32 v[66:67], v[90:91], v[26:27], v[66:67] op_sel:[0,1,0]
    v_pk_fma_f32 v[68:69], v[92:93], v[26:27], v[68:69] op_sel:[0,1,0]
    v_pk_fma_f32 v[70:71], v[94:95], v[26:27], v[70:71] op_sel:[0,1,0]
    v_cvt_pk_bf16_f32 v40, v64, v65
    v_cvt_pk_bf16_f32 v41, v66, v67
    v_cvt_pk_bf16_f32 v42, v68, v69
    v_cvt_pk_bf16_f32 v43, v70, v71
    s_nop 1
    v_mfma_f32_16x16x32_bf16 v[96:99], v[40:43], v[128:131], 0
    v_mfma_f32_16x16x32_bf16 v[100:103], v[40:43], v[132:135], 0
    v_mfma_f32_16x16x32_bf16 v[104:107], v[40:43], v[136:139], 0
    v_mfma_f32_16x16x32_bf16 v[108:111], v[40:43], v[140:143], 0
    v_mfma_f32_16x16x32_bf16 v[112:115], v[40:43], v[144:147], 0
    v_mfma_f32_16x16x32_bf16 v[116:119], v[40:43], v[148:151], 0
    v_mfma_f32_16x16x32_bf16 v[120:123], v[40:43], v[152:155], 0
    v_mfma_f32_16x16x32_bf16 v[124:127], v[40:43], v[156:159], 0
    s_nop 2
    v_cndmask_b32 v60, v96, v104, s[42:43]
    v_cndmask_b32 v61, v100, v108, s[42:43]
    v_cndmask_b32 v60, v60, v112, s[44:45]
    v_cndmask_b32 v61, v61, v116, s[44:45]
    v_cndmask_b32 v60, v60, v120, s[46:47]
    v_cndmask_b32 v61, v61, v124, s[46:47]
    v_bfi_b32 v60, v8, s40, v60
    v_bfi_b32 v61, v8, s40, v61
    buffer_store_dwordx2 v[60:61], v205, s[24:27], s60 offen
    buffer_store_dwordx2 v[60:61], v205, s[24:27], s61 offen sc1
    s_cmp_ge_u32 s2, 40
    s_cbranch_scc1 X_FIN
    s_mov_b32 exec_hi, 0
FP_13:
    buffer_load_dword v19, v232, s[24:27], s17 offen sc1
    s_sub_u32 s41, s41, 1
    s_cmp_lt_i32 s41, 0
    s_cbranch_scc1 FD_14
    s_waitcnt vmcnt(0)
    v_cmp_ne_u32 vcc, s40, v19
    s_cbranch_vccnz FP_13
FD_14:
    s_mov_b32 exec_hi, -1
X_YF:
    buffer_load_dwordx4 v[236:239], v229, s[24:27], s14 offen sc1
    buffer_load_dwordx4 v[240:243], v230, s[24:27], s14 offen sc1
    s_sub_u32 s41, s41, 1
    s_cmp_lt_i32 s41, 0
    s_cbranch_scc1 X_YG
    s_waitcnt vmcnt(0)
    v_xor_b32 v19, s40, v236
    v_bitop3_b32 v19, v19, v237, s40 bitop3:0xf6
    v_bitop3_b32 v19, v19, v238, s40 bitop3:0xf6
    v_bitop3_b32 v19, v19, v239, s40 bitop3:0xf6
    v_bitop3_b32 v19, v19, v240, s40 bitop3:0xf6
    v_bitop3_b32 v19, v19, v241, s40 bitop3:0xf6
    v_bitop3_b32 v19, v19, v242, s40 bitop3:0xf6
    v_bitop3_b32 v19, v19, v243, s40 bitop3:0xf6
    v_and_b32 v19, v8, v19
    v_cmp_ne_u32 vcc, 0, v19
    s_cbranch_vccnz X_YF
X_YG:
    v_cndmask_b32 v240, 0, v240, s[18:19]
    v_cndmask_b32 v241, 0, v241, s[18:19]
    v_cndmask_b32 v242, 0, v242, s[18:19]
    v_cndmask_b32 v243, 0, v243, s[18:19]
    v_pk_add_f32 v[24:25], v[236:237], v[240:241]
    v_pk_add_f32 v[26:27], v[238:239], v[242:243]
    s_nop 1
    v_permlane32_swap_b32 v24, v25
    v_permlane32_swap_b32 v26, v27
    v_add_f32 v24, v24, v25
    v_add_f32 v26, v26, v27
    s_nop 1
    v_permlane16_swap_b32 v24, v26
    v_add_f32 v24, v24, v26
    s_nop 1
    v_add_f32_dpp v24, v24, v24 row_ror:8 row_mask:0xf bank_mask:0xf
    s_nop 1
    v_add_f32_dpp v24, v24, v24 row_ror:4 row_mask:0xf bank_mask:0xf
    ds_write_b32 v233, v24 offset:42816
    s_waitcnt lgkmcnt(0)
    s_barrier
    s_cmp_lg_u32 s3, 0
    s_cbranch_scc1 W0_15
    ds_read_b32 v24, v234 offset:42816
    ds_read_b32 v25, v234 offset:42880
    ds_read_b32 v26, v234 offset:42944
    ds_read_b32 v27, v234 offset:43008
    s_waitcnt lgkmcnt(0)
    v_add_f32 v24, v24, v25
    v_add_f32 v26, v26, v27
    v_add_f32 v24, v24, v26
    v_cvt_pk_bf16_f32 v24, v24, v24
    v_and_b32 v24, 0xffff0000, v24
    v_mul_f32 v25, 0xbfb8aa3b, v24
    v_exp_f32 v25, v25
    s_nop 0
    v_add_f32 v25, 1.0, v25
    v_rcp_f32 v25, v25
    s_nop 0
    v_mul_f32 v28, v24, v25
    v_cvt_pk_bf16_f32 v28, v28, v28
    v_and_b32 v28, 0xffff0000, v28
    v_lshlrev_b32 v235, 16, v235
W0_15:
    s_mov_b64 exec, 0xff
FP_16:
    buffer_load_dword v19, v231, s[24:27], s13 offen sc1
    s_sub_u32 s41, s41, 1
    s_cmp_lt_i32 s41, 0
    s_cbranch_scc1 FD_17
    s_waitcnt vmcnt(0)
    v_cmp_ne_u32 vcc, s40, v19
    s_cbranch_vccnz FP_16
FD_17:
    s_mov_b64 exec, -1
X_SF:
    buffer_load_dwordx4 v[64:67], v229, s[24:27], s15 offen sc1
    buffer_load_dwordx4 v[68:71], v229, s[24:27], s16 offen sc1
    s_sub_u32 s41, s41, 1
    s_cmp_lt_i32 s41, 0
    s_cbranch_scc1 X_SG
    s_waitcnt vmcnt(0)
    v_pk_add_f32 v[20:21], v[64:65], v[68:69]
    v_pk_add_f32 v[22:23], v[66:67], v[70:71]
    v_xor_b32 v19, s40, v64
    v_bitop3_b32 v19, v19, v65, s40 bitop3:0xf6
    v_bitop3_b32 v19, v19, v66, s40 bitop3:0xf6
    v_bitop3_b32 v19, v19, v67, s40 bitop3:0xf6
    v_bitop3_b32 v19, v19, v68, s40 bitop3:0xf6
    v_bitop3_b32 v19, v19, v69, s40 bitop3:0xf6
    v_bitop3_b32 v19, v19, v70, s40 bitop3:0xf6
    v_bitop3_b32 v19, v19, v71, s40 bitop3:0xf6
    v_and_b32 v19, v8, v19
    v_cmp_ne_u32 vcc, 0, v19
    s_cbranch_vccnz X_SF
X_SG:
    v_permlane32_swap_b32 v20, v21
    v_permlane32_swap_b32 v22, v23
    v_add_f32 v20, v20, v21
    v_add_f32 v22, v22, v23
    s_nop 1
    v_permlane16_swap_b32 v20, v22
    v_add_f32 v20, v20, v22
    s_nop 1
    v_add_f32_dpp v20, v20, v20 row_ror:8 row_mask:0xf bank_mask:0xf
    s_nop 1
    v_add_f32_dpp v20, v20, v20 row_ror:4 row_mask:0xf bank_mask:0xf
    ds_write_b32 v233, v20 offset:42560
    s_waitcnt lgkmcnt(0)
    s_barrier
    s_cmp_lg_u32 s3, 0
    s_cbranch_scc1 X_FIN
    s_mov_b64 exec, 0xffff
    ds_read_b32 v20, v234 offset:42560
    ds_read_b32 v21, v234 offset:42624
    ds_read_b32 v22, v234 offset:42688
    ds_read_b32 v23, v234 offset:42752
    s_waitcnt lgkmcnt(0)
    v_add_f32 v20, v20, v21
    v_add_f32 v22, v22, v23
    v_add_f32 v20, v20, v22
    v_cvt_pk_bf16_f32 v20, v20, v20
    v_and_b32 v20, 0xffff0000, v20
    v_mul_f32 v20, v20, v28
    v_cvt_pk_bf16_f32 v20, v20, v20
    v_and_b32 v20, 0xffff0000, v20
    v_add_f32 v20, v20, v235
    v_cvt_pk_bf16_f32 v20, v20, v20
    buffer_store_short v20, v228, s[36:39], s12 offen
    s_cmp_lg_u32 s2, 0
    s_cbranch_scc1 X_FIN
    v_mov_b32 v9, 0
    s_mov_b64 exec, 1
    buffer_store_dword v211, v9, s[24:27], 0 offen offset:0 sc1
X_FIN:
    s_endpgm
L_Y:
    s_cmp_lg_u32 s3, 0
    s_cbranch_scc1 W0_18
    s_mov_b32 exec_hi, 0
    buffer_store_dwordx4 v[60:63], v204, s[24:27], s55 offen sc1
    s_mov_b32 exec_hi, -1
W0_18:
    s_lshl_b32 s53, s60, 1
    s_sub_u32 s60, s2, 128
    s_mov_b32 s62, s58
    s_add_u32 s56, s56, 4096
    s_add_u32 s57, s57, 4096
    v_xor_b32 v68, 8, v1
    v_lshlrev_b32 v68, 4, v68
    s_mov_b32 m0, s57
    s_add_u32 s57, s57, 1024
    buffer_load_dwordx4 v68, s[20:23], s56 offen  lds
    s_add_u32 s56, s56, 1024
    v_xor_b32 v69, 10, v1
    v_lshlrev_b32 v69, 4, v69
    s_mov_b32 m0, s57
    s_add_u32 s57, s57, 1024
    buffer_load_dwordx4 v69, s[20:23], s56 offen  lds
    s_add_u32 s56, s56, 1024
    v_xor_b32 v70, 12, v1
    v_lshlrev_b32 v70, 4, v70
    s_mov_b32 m0, s57
    s_add_u32 s57, s57, 1024
    buffer_load_dwordx4 v70, s[20:23], s56 offen  lds
    s_add_u32 s56, s56, 1024
    v_xor_b32 v71, 14, v1
    v_lshlrev_b32 v71, 4, v71
    s_mov_b32 m0, s57
    s_add_u32 s57, s57, 1024
    buffer_load_dwordx4 v71, s[20:23], s56 offen  lds
    s_add_u32 s56, s56, 1024
    s_load_dwordx2 s[12:13], s[0:1], 72
    s_mov_b32 s14, 0x21c000
    s_mov_b32 s15, 0x20000
    s_load_dwordx2 s[32:33], s[0:1], 40
    s_mov_b32 s34, 0x500000
    s_mov_b32 s35, 0x20000
    v_lshlrev_b32 v19, 7, v1
    s_lshl_b32 s6, s62, 2
    s_add_u32 s6, s6, s3
    s_lshl_b32 s7, s6, 12
    s_add_u32 s54, s7, 98304
    s_lshl_b32 s7, s6, 10
    s_add_u32 s55, s7, 131072
    s_lshl_b32 s7, s6, 9
    s_and_b32 s6, s2, 7
    s_lshl_b32 s6, s6, 12
    s_add_u32 s7, s7, s6
    s_add_u32 s58, s7, 4096
    s_mov_b64 exec, 0xf
    buffer_load_dword v40, v19, s[24:27], s58 offen sc1
    s_mov_b64 exec, -1
    s_lshl_b32 s6, s4, 13
    s_lshl_b32 s7, s5, 7
    s_add_u32 s6, s6, s7
    s_lshl_b32 s7, s3, 5
    s_add_u32 s6, s6, s7
    s_add_u32 s28, s6, 458752
    s_add_u32 s29, s6, 720896
    v_lshlrev_b32 v57, 9, v2
    v_lshl_add_u32 v57, v3, 3, v57
    buffer_load_dword v40, v57, s[24:27], s28 offen
    v_xor_b32 v64, 0, v1
    v_lshlrev_b32 v64, 4, v64
    s_mov_b32 m0, s57
    s_add_u32 s57, s57, 1024
    buffer_load_dwordx4 v64, s[20:23], s56 offen  lds
    s_add_u32 s56, s56, 1024
    v_xor_b32 v65, 2, v1
    v_lshlrev_b32 v65, 4, v65
    s_mov_b32 m0, s57
    s_add_u32 s57, s57, 1024
    buffer_load_dwordx4 v65, s[20:23], s56 offen  lds
    s_add_u32 s56, s56, 1024
    v_xor_b32 v66, 4, v1
    v_lshlrev_b32 v66, 4, v66
    s_mov_b32 m0, s57
    s_add_u32 s57, s57, 1024
    buffer_load_dwordx4 v66, s[20:23], s56 offen  lds
    s_add_u32 s56, s56, 1024
    v_xor_b32 v67, 6, v1
    v_lshlrev_b32 v67, 4, v67
    s_mov_b32 m0, s57
    s_add_u32 s57, s57, 1024
    buffer_load_dwordx4 v67, s[20:23], s56 offen  lds
    s_add_u32 s56, s56, 1024
    s_mov_b32 m0, s57
    s_add_u32 s57, s57, 1024
    buffer_load_dwordx4 v68, s[20:23], s56 offen  lds
    s_add_u32 s56, s56, 1024
    s_mov_b32 m0, s57
    s_add_u32 s57, s57, 1024
    buffer_load_dwordx4 v69, s[20:23], s56 offen  lds
    s_add_u32 s56, s56, 1024
    s_mov_b32 m0, s57
    s_add_u32 s57, s57, 1024
    buffer_load_dwordx4 v70, s[20:23], s56 offen  lds
    s_add_u32 s56, s56, 1024
    s_mov_b32 m0, s57
    s_add_u32 s57, s57, 1024
    buffer_load_dwordx4 v71, s[20:23], s56 offen  lds
    s_add_u32 s56, s56, 1024
    s_sub_u32 s56, s56, s53
    s_mov_b32 m0, s57
    s_add_u32 s57, s57, 1024
    buffer_load_dwordx4 v64, s[20:23], s56 offen  lds
    s_add_u32 s56, s56, 1024
    s_mov_b32 m0, s57
    s_add_u32 s57, s57, 1024
    buffer_load_dwordx4 v65, s[20:23], s56 offen  lds
    s_add_u32 s56, s56, 1024
    s_mov_b32 m0, s57
    s_add_u32 s57, s57, 1024
    buffer_load_dwordx4 v66, s[20:23], s56 offen  lds
    s_add_u32 s56, s56, 1024
    s_mov_b32 m0, s57
    s_add_u32 s57, s57, 1024
    buffer_load_dwordx4 v67, s[20:23], s56 offen  lds
    s_add_u32 s56, s56, 1024
    s_mov_b32 m0, s57
    s_add_u32 s57, s57, 1024
    buffer_load_dwordx4 v68, s[20:23], s56 offen  lds
    s_add_u32 s56, s56, 1024
    s_mov_b32 m0, s57
    s_add_u32 s57, s57, 1024
    buffer_load_dwordx4 v69, s[20:23], s56 offen  lds
    s_add_u32 s56, s56, 1024
    s_mov_b32 m0, s57
    s_add_u32 s57, s57, 1024
    buffer_load_dwordx4 v70, s[20:23], s56 offen  lds
    s_add_u32 s56, s56, 1024
    s_mov_b32 m0, s57
    s_add_u32 s57, s57, 1024
    buffer_load_dwordx4 v71, s[20:23], s56 offen  lds
    s_add_u32 s56, s56, 1024
    s_mov_b32 m0, s57
    s_add_u32 s57, s57, 1024
    buffer_load_dwordx4 v64, s[20:23], s56 offen  lds
    s_add_u32 s56, s56, 1024
    s_mov_b32 m0, s57
    s_add_u32 s57, s57, 1024
    buffer_load_dwordx4 v65, s[20:23], s56 offen  lds
    s_add_u32 s56, s56, 1024
    s_mov_b32 m0, s57
    s_add_u32 s57, s57, 1024
    buffer_load_dwordx4 v66, s[20:23], s56 offen  lds
    s_add_u32 s56, s56, 1024
    s_mov_b32 m0, s57
    s_add_u32 s57, s57, 1024
    buffer_load_dwordx4 v67, s[20:23], s56 offen  lds
    s_add_u32 s56, s56, 1024
    s_mov_b32 m0, s57
    s_add_u32 s57, s57, 1024
    buffer_load_dwordx4 v68, s[20:23], s56 offen  lds
    s_add_u32 s56, s56, 1024
    s_mov_b32 m0, s57
    s_add_u32 s57, s57, 1024
    buffer_load_dwordx4 v69, s[20:23], s56 offen  lds
    s_add_u32 s56, s56, 1024
    s_mov_b32 m0, s57
    s_add_u32 s57, s57, 1024
    buffer_load_dwordx4 v70, s[20:23], s56 offen  lds
    s_add_u32 s56, s56, 1024
    s_mov_b32 m0, s57
    s_add_u32 s57, s57, 1024
    buffer_load_dwordx4 v71, s[20:23], s56 offen  lds
    s_add_u32 s56, s56, 1024
    s_mov_b64 exec, 0xf
    buffer_load_dword v40, v19, s[24:27], s58 offen sc1
    s_mov_b64 exec, -1
    v_mov_b32 v18, v204
    v_mov_b32 v59, v211
    v_and_b32 v9, 7, v2
    v_lshlrev_b32 v9, 1, v9
    v_xor_b32 v9, v9, v3
    v_lshlrev_b32 v9, 4, v9
    v_lshl_add_u32 v9, v2, 10, v9
    s_lshl_b32 s7, s3, 15
    v_add_u32 v20, s7, v9
    v_add_u32 v24, 131072, v9
    v_xor_b32 v21, 64, v20
    v_xor_b32 v25, 64, v24
    v_xor_b32 v22, 128, v20
    v_xor_b32 v26, 128, v24
    v_xor_b32 v23, 192, v20
    v_xor_b32 v27, 192, v24
    v_bfe_u32 v9, v1, 2, 2
    v_lshl_add_u32 v9, v3, 2, v9
    v_and_b32 v10, 7, v9
    v_lshlrev_b32 v10, 5, v10
    v_lshl_add_u32 v10, v9, 10, v10
    v_and_b32 v9, 3, v1
    v_lshl_add_u32 v10, v9, 3, v10
    s_lshl_b32 s7, s3, 8
    v_add_u32 v28, s7, v10
    v_xor_b32 v29, 32, v28
    v_xor_b32 v30, 64, v28
    v_xor_b32 v31, 96, v28
    v_xor_b32 v32, 128, v28
    v_xor_b32 v33, 160, v28
    v_xor_b32 v34, 192, v28
    v_xor_b32 v35, 224, v28
    s_and_b32 s7, s3, 1
    s_lshl_b32 s7, s7, 3
    v_xor_b32 v9, s7, v1
    v_lshlrev_b32 v9, 4, v9
    s_lshl_b32 s7, s3, 12
    s_add_u32 s7, s7, 131072
    v_add_u32 v36, s7, v9
    v_xor_b32 v37, 32, v36
    v_xor_b32 v38, 64, v36
    v_xor_b32 v39, 96, v36
    v_lshlrev_b32 v17, 2, v1
    v_lshlrev_b32 v9, 4, v2
    v_add_u32 v10, 151552, v9
    s_lshl_b32 s7, s3, 2
    v_add_u32 v11, s7, v10
    v_lshlrev_b32 v9, 6, v2
    v_add_u32 v15, 151808, v9
    s_lshl_b32 s7, s3, 4
    v_lshl_add_u32 v16, v3, 2, s7
    v_add_u32 v16, v16, v15
    v_add_u32 v12, 147456, v18
    s_lshl_b32 s7, s3, 10
    v_add_u32 v13, s7, v12
    v_lshlrev_b32 v61, 18, v3
    v_lshl_add_u32 v61, v2, 4, v61
    v_lshlrev_b32 v62, 16, v3
    v_lshl_add_u32 v62, v2, 2, v62
    s_lshl_b32 s6, s62, 6
    s_add_u32 s6, s6, s3
    s_lshl_b32 s6, s6, 6
    s_add_u32 s6, s6, s61
    s_lshl_b32 s7, s6, 8
    s_add_u32 s36, s7, 2097152
    s_lshl_b32 s7, s6, 6
    s_add_u32 s64, s7, 4194304
    s_add_u32 s37, s36, 65536
    s_add_u32 s65, s64, 16384
    s_add_u32 s38, s36, 131072
    s_add_u32 s66, s64, 32768
    s_add_u32 s39, s36, 196608
    s_add_u32 s67, s64, 49152
    s_lshl_b32 s6, s62, 6
    s_add_u32 s6, s6, s61
    s_lshl_b32 s6, s6, 9
    s_add_u32 s57, s6, 983040
    v_lshlrev_b32 v63, 5, v2
    v_lshl_add_u32 v63, v3, 4, v63
    s_mov_b32 s52, 0x3db504f3
    s_mov_b32 s53, s52
    s_mov_b32 s56, 0x3fb8aa3b
    s_lshl_b32 s6, s4, 6
    s_lshl_b32 s7, s5, 4
    s_add_u32 s6, s6, s7
    s_lshl_b32 s7, s3, 2
    s_add_u32 s6, s6, s7
    s_mul_i32 s63, s6, 1280
    s_lshl_b32 s6, s6, 1
    s_sub_u32 s6, s6, s7
    s_mul_i32 s30, s6, 1280
    s_add_u32 s31, s30, 20480
    v_mul_u32_u24 v55, 1280, v3
    v_lshl_add_u32 v55, v2, 4, v55
    v_and_b32 v56, 7, v2
    v_lshlrev_b32 v56, 8, v56
    v_lshl_add_u32 v56, v3, 2, v56
    s_lshl_b32 s6, s4, 11
    s_lshl_b32 s7, s5, 6
    s_add_u32 s6, s6, s7
    s_lshl_b32 s7, s3, 4
    s_add_u32 s6, s6, s7
    s_add_u32 s48, s6, 327680
    s_add_u32 s49, s6, 393216
    s_waitcnt vmcnt(17)
    ds_read_b128 v[128:131], v20 offset:0
    ds_read_b128 v[132:135], v21 offset:0
    ds_read_b128 v[136:139], v22 offset:0
    ds_read_b128 v[140:143], v23 offset:0
    ds_read_b128 v[144:147], v20 offset:256
    ds_read_b128 v[148:151], v21 offset:256
    ds_read_b128 v[152:155], v22 offset:256
    ds_read_b128 v[156:159], v23 offset:256
    ds_read_b128 v[160:163], v20 offset:512
    ds_read_b128 v[164:167], v21 offset:512
    ds_read_b128 v[168:171], v22 offset:512
    ds_read_b128 v[172:175], v23 offset:512
    ds_read_b128 v[176:179], v20 offset:768
    ds_read_b128 v[180:183], v21 offset:768
    ds_read_b128 v[184:187], v22 offset:768
    ds_read_b128 v[188:191], v23 offset:768
    s_mov_b64 exec, 0xf
    s_waitcnt vmcnt(0)
    v_cmp_ne_u32 vcc, s40, v40
    s_mov_b64 exec, -1
    s_cbranch_vccnz Y_WAIT
    buffer_load_dwordx4 v[64:67], v18, s[24:27], s54 offen offset:0 sc1
    buffer_load_dwordx4 v[68:71], v18, s[24:27], s54 offen offset:1024 sc1
    buffer_load_dwordx4 v[72:75], v18, s[24:27], s54 offen offset:2048 sc1
    buffer_load_dwordx4 v[76:79], v18, s[24:27], s54 offen offset:3072 sc1
    buffer_load_dword v80, v17, s[24:27], s55 offen offset:0 sc1
    buffer_load_dword v81, v17, s[24:27], s55 offen offset:256 sc1
    buffer_load_dword v82, v17, s[24:27], s55 offen offset:512 sc1
    buffer_load_dword v83, v17, s[24:27], s55 offen offset:768 sc1
Y_WAIT:
    s_mov_b64 s[42:43], vcc
    ds_read_b128 v[192:195], v20 offset:16384
    ds_read_b128 v[196:199], v21 offset:16384
    ds_read_b128 v[200:203], v22 offset:16384
    ds_read_b128 v[204:207], v23 offset:16384
    ds_read_b128 v[208:211], v20 offset:16640
    ds_read_b128 v[212:215], v21 offset:16640
    ds_read_b128 v[216:219], v22 offset:16640
    ds_read_b128 v[220:223], v23 offset:16640
    ds_read_b128 v[224:227], v20 offset:16896
    ds_read_b128 v[228:231], v21 offset:16896
    ds_read_b128 v[232:235], v22 offset:16896
    ds_read_b128 v[236:239], v23 offset:16896
    ds_read_b128 v[240:243], v20 offset:17152
    ds_read_b128 v[244:247], v21 offset:17152
    ds_read_b128 v[248:251], v22 offset:17152
    ds_read_b128 v[252:255], v23 offset:17152
    s_barrier
    ds_read_b64_tr_b16 a[0:1], v28 offset:0
    ds_read_b64_tr_b16 a[2:3], v28 offset:16384
    ds_read_b64_tr_b16 a[4:5], v29 offset:0
    ds_read_b64_tr_b16 a[6:7], v29 offset:16384
    ds_read_b64_tr_b16 a[8:9], v30 offset:0
    ds_read_b64_tr_b16 a[10:11], v30 offset:16384
    ds_read_b64_tr_b16 a[12:13], v31 offset:0
    ds_read_b64_tr_b16 a[14:15], v31 offset:16384
    ds_read_b64_tr_b16 a[16:17], v32 offset:0
    ds_read_b64_tr_b16 a[18:19], v32 offset:16384
    ds_read_b64_tr_b16 a[20:21], v33 offset:0
    ds_read_b64_tr_b16 a[22:23], v33 offset:16384
    ds_read_b64_tr_b16 a[24:25], v34 offset:0
    ds_read_b64_tr_b16 a[26:27], v34 offset:16384
    ds_read_b64_tr_b16 a[28:29], v35 offset:0
    ds_read_b64_tr_b16 a[30:31], v35 offset:16384
    ds_read_b64_tr_b16 a[32:33], v28 offset:32768
    ds_read_b64_tr_b16 a[34:35], v28 offset:49152
    ds_read_b64_tr_b16 a[36:37], v29 offset:32768
    ds_read_b64_tr_b16 a[38:39], v29 offset:49152
    ds_read_b64_tr_b16 a[40:41], v30 offset:32768
    ds_read_b64_tr_b16 a[42:43], v30 offset:49152
    ds_read_b64_tr_b16 a[44:45], v31 offset:32768
    ds_read_b64_tr_b16 a[46:47], v31 offset:49152
    ds_read_b64_tr_b16 a[48:49], v32 offset:32768
    ds_read_b64_tr_b16 a[50:51], v32 offset:49152
    ds_read_b64_tr_b16 a[52:53], v33 offset:32768
    ds_read_b64_tr_b16 a[54:55], v33 offset:49152
    ds_read_b64_tr_b16 a[56:57], v34 offset:32768
    ds_read_b64_tr_b16 a[58:59], v34 offset:49152
    ds_read_b64_tr_b16 a[60:61], v35 offset:32768
    ds_read_b64_tr_b16 a[62:63], v35 offset:49152
    v_add_u32 v28, 0x10000, v28
    v_add_u32 v29, 0x10000, v29
    v_add_u32 v30, 0x10000, v30
    v_add_u32 v31, 0x10000, v31
    v_add_u32 v32, 0x10000, v32
    v_add_u32 v33, 0x10000, v33
    v_add_u32 v34, 0x10000, v34
    v_add_u32 v35, 0x10000, v35
    ds_read_b64_tr_b16 a[64:65], v28 offset:0
    ds_read_b64_tr_b16 a[66:67], v28 offset:16384
    ds_read_b64_tr_b16 a[68:69], v29 offset:0
    ds_read_b64_tr_b16 a[70:71], v29 offset:16384
    ds_read_b64_tr_b16 a[72:73], v30 offset:0
    ds_read_b64_tr_b16 a[74:75], v30 offset:16384
    ds_read_b64_tr_b16 a[76:77], v31 offset:0
    ds_read_b64_tr_b16 a[78:79], v31 offset:16384
    ds_read_b64_tr_b16 a[80:81], v32 offset:0
    ds_read_b64_tr_b16 a[82:83], v32 offset:16384
    ds_read_b64_tr_b16 a[84:85], v33 offset:0
    ds_read_b64_tr_b16 a[86:87], v33 offset:16384
    ds_read_b64_tr_b16 a[88:89], v34 offset:0
    ds_read_b64_tr_b16 a[90:91], v34 offset:16384
    ds_read_b64_tr_b16 a[92:93], v35 offset:0
    ds_read_b64_tr_b16 a[94:95], v35 offset:16384
    ds_read_b64_tr_b16 a[96:97], v28 offset:32768
    ds_read_b64_tr_b16 a[98:99], v28 offset:49152
    ds_read_b64_tr_b16 a[100:101], v29 offset:32768
    ds_read_b64_tr_b16 a[102:103], v29 offset:49152
    ds_read_b64_tr_b16 a[104:105], v30 offset:32768
    ds_read_b64_tr_b16 a[106:107], v30 offset:49152
    ds_read_b64_tr_b16 a[108:109], v31 offset:32768
    ds_read_b64_tr_b16 a[110:111], v31 offset:49152
    ds_read_b64_tr_b16 a[112:113], v32 offset:32768
    ds_read_b64_tr_b16 a[114:115], v32 offset:49152
    ds_read_b64_tr_b16 a[116:117], v33 offset:32768
    ds_read_b64_tr_b16 a[118:119], v33 offset:49152
    ds_read_b64_tr_b16 a[120:121], v34 offset:32768
    ds_read_b64_tr_b16 a[122:123], v34 offset:49152
    ds_read_b64_tr_b16 a[124:125], v35 offset:32768
    ds_read_b64_tr_b16 a[126:127], v35 offset:49152
    s_cmp_eq_u64 s[42:43], 0
    s_cbranch_scc1 Y_QW
    s_mov_b64 exec, 0xf
FP_19:
    buffer_load_dword v40, v19, s[24:27], s58 offen sc1
    s_sub_u32 s41, s41, 1
    s_cmp_lt_i32 s41, 0
    s_cbranch_scc1 FD_20
    s_waitcnt vmcnt(0)
    v_cmp_ne_u32 vcc, s40, v40
    s_cbranch_vccnz FP_19
FD_20:
    s_mov_b64 exec, -1
Y_QR:
    buffer_load_dwordx4 v[64:67], v18, s[24:27], s54 offen offset:0 sc1
    buffer_load_dwordx4 v[68:71], v18, s[24:27], s54 offen offset:1024 sc1
    buffer_load_dwordx4 v[72:75], v18, s[24:27], s54 offen offset:2048 sc1
    buffer_load_dwordx4 v[76:79], v18, s[24:27], s54 offen offset:3072 sc1
    buffer_load_dword v80, v17, s[24:27], s55 offen offset:0 sc1
    buffer_load_dword v81, v17, s[24:27], s55 offen offset:256 sc1
    buffer_load_dword v82, v17, s[24:27], s55 offen offset:512 sc1
    buffer_load_dword v83, v17, s[24:27], s55 offen offset:768 sc1
Y_QW:
    s_waitcnt vmcnt(0)
    ds_write_b128 v36, v[64:67] offset:0
    ds_write_b128 v37, v[68:71] offset:1024
    ds_write_b128 v38, v[72:75] offset:2048
    ds_write_b128 v39, v[76:79] offset:3072
    v_add3_u32 v9, v64, v65, s59
    v_add3_u32 v40, v80, v81, v82
    v_add3_u32 v9, v66, v67, v9
    v_add3_u32 v9, v68, v69, v9
    v_add3_u32 v9, v70, v71, v9
    v_add3_u32 v9, v72, v73, v9
    v_add3_u32 v9, v74, v75, v9
    v_add3_u32 v9, v76, v77, v9
    v_add3_u32 v9, v78, v79, v9
    v_add_u32 v40, v40, v83
    v_cmp_ne_u32 vcc, v9, v40
    s_cbranch_vccz Y_QD
    s_sub_u32 s41, s41, 1
    s_cmp_lt_i32 s41, 0
    s_cbranch_scc0 Y_QR
Y_QD:
    s_waitcnt lgkmcnt(0)
    s_barrier
    ds_read_b128 v[64:67], v24 offset:0
    ds_read_b128 v[68:71], v25 offset:0
    ds_read_b128 v[72:75], v26 offset:0
    ds_read_b128 v[76:79], v27 offset:0
    ds_read_b128 v[80:83], v24 offset:256
    ds_read_b128 v[84:87], v25 offset:256
    ds_read_b128 v[88:91], v26 offset:256
    ds_read_b128 v[92:95], v27 offset:256
    s_waitcnt lgkmcnt(7)
    v_mfma_f32_16x16x32_bf16 v[40:43], v[128:131], v[64:67], 0
    ds_read_b128 v[96:99], v24 offset:512
    s_waitcnt lgkmcnt(7)
    v_mfma_f32_16x16x32_bf16 v[40:43], v[132:135], v[68:71], v[40:43]
    ds_read_b128 v[100:103], v25 offset:512
    s_waitcnt lgkmcnt(7)
    v_mfma_f32_16x16x32_bf16 v[40:43], v[136:139], v[72:75], v[40:43]
    ds_read_b128 v[104:107], v26 offset:512
    s_waitcnt lgkmcnt(7)
    v_mfma_f32_16x16x32_bf16 v[40:43], v[140:143], v[76:79], v[40:43]
    ds_read_b128 v[108:111], v27 offset:512
    s_waitcnt lgkmcnt(7)
    v_mfma_f32_16x16x32_bf16 v[40:43], v[144:147], v[80:83], v[40:43]
    ds_read_b128 v[112:115], v24 offset:768
    s_waitcnt lgkmcnt(7)
    v_mfma_f32_16x16x32_bf16 v[40:43], v[148:151], v[84:87], v[40:43]
    ds_read_b128 v[116:119], v25 offset:768
    s_waitcnt lgkmcnt(7)
    v_mfma_f32_16x16x32_bf16 v[40:43], v[152:155], v[88:91], v[40:43]
    ds_read_b128 v[120:123], v26 offset:768
    s_waitcnt lgkmcnt(7)
    v_mfma_f32_16x16x32_bf16 v[40:43], v[156:159], v[92:95], v[40:43]
    ds_read_b128 v[124:127], v27 offset:768
    s_waitcnt lgkmcnt(7)
    v_mfma_f32_16x16x32_bf16 v[40:43], v[160:163], v[96:99], v[40:43]
    buffer_load_dwordx4 a[128:131], v55, s[12:15], s63 offen offset:0
    s_waitcnt lgkmcnt(6)
    v_mfma_f32_16x16x32_bf16 v[40:43], v[164:167], v[100:103], v[40:43]
    s_waitcnt lgkmcnt(5)
    v_mfma_f32_16x16x32_bf16 v[40:43], v[168:171], v[104:107], v[40:43]
    s_waitcnt lgkmcnt(4)
    v_mfma_f32_16x16x32_bf16 v[40:43], v[172:175], v[108:111], v[40:43]
    s_waitcnt lgkmcnt(3)
    v_mfma_f32_16x16x32_bf16 v[40:43], v[176:179], v[112:115], v[40:43]
    buffer_load_dwordx4 a[132:135], v55, s[12:15], s63 offen offset:256
    s_waitcnt lgkmcnt(2)
    v_mfma_f32_16x16x32_bf16 v[40:43], v[180:183], v[116:119], v[40:43]
    s_waitcnt lgkmcnt(1)
    v_mfma_f32_16x16x32_bf16 v[40:43], v[184:187], v[120:123], v[40:43]
    s_waitcnt lgkmcnt(0)
    v_mfma_f32_16x16x32_bf16 v[40:43], v[188:191], v[124:127], v[40:43]
    v_mfma_f32_16x16x32_bf16 v[44:47], v[192:195], v[64:67], 0
    buffer_load_dwordx4 a[136:139], v55, s[12:15], s63 offen offset:512
    s_nop 1
    v_mfma_f32_16x16x32_bf16 v[44:47], v[196:199], v[68:71], v[44:47]
    s_nop 1
    v_mfma_f32_16x16x32_bf16 v[44:47], v[200:203], v[72:75], v[44:47]
    s_nop 1
    v_mfma_f32_16x16x32_bf16 v[44:47], v[204:207], v[76:79], v[44:47]
    v_cvt_pk_bf16_f32 v48, v40, v41
    v_mfma_f32_16x16x32_bf16 v[44:47], v[208:211], v[80:83], v[44:47]
    buffer_load_dwordx4 a[140:143], v55, s[12:15], s63 offen offset:768
    v_cvt_pk_bf16_f32 v49, v42, v43
    v_mfma_f32_16x16x32_bf16 v[44:47], v[212:215], v[84:87], v[44:47]
    v_lshlrev_b32 v40, 16, v48
    v_mfma_f32_16x16x32_bf16 v[44:47], v[216:219], v[88:91], v[44:47]
    v_and_b32 v41, 0xffff0000, v48
    v_mfma_f32_16x16x32_bf16 v[44:47], v[220:223], v[92:95], v[44:47]
    buffer_load_dwordx4 a[144:147], v55, s[12:15], s63 offen offset:1024
    v_lshlrev_b32 v42, 16, v49
    v_mfma_f32_16x16x32_bf16 v[44:47], v[224:227], v[96:99], v[44:47]
    v_and_b32 v43, 0xffff0000, v49
    v_mul_f32 v40, s52, v40
    v_mfma_f32_16x16x32_bf16 v[44:47], v[228:231], v[100:103], v[44:47]
    v_mul_f32 v41, s52, v41
    v_mul_f32 v42, s52, v42
    v_mfma_f32_16x16x32_bf16 v[44:47], v[232:235], v[104:107], v[44:47]
    v_mul_f32 v43, s52, v43
    v_cvt_pk_bf16_f32 v48, v40, v41
    v_mfma_f32_16x16x32_bf16 v[44:47], v[236:239], v[108:111], v[44:47]
    v_cvt_pk_bf16_f32 v49, v42, v43
    v_lshlrev_b32 v40, 16, v48
    v_mfma_f32_16x16x32_bf16 v[44:47], v[240:243], v[112:115], v[44:47]
    v_and_b32 v41, 0xffff0000, v48
    v_lshlrev_b32 v42, 16, v49
    v_mfma_f32_16x16x32_bf16 v[44:47], v[244:247], v[116:119], v[44:47]
    v_and_b32 v43, 0xffff0000, v49
    v_max3_f32 v50, v40, v41, v42
    v_mfma_f32_16x16x32_bf16 v[44:47], v[248:251], v[120:123], v[44:47]
    v_max_f32 v50, v50, v43
    v_mfma_f32_16x16x32_bf16 v[44:47], v[252:255], v[124:127], v[44:47]
    s_nop 7
    v_cvt_pk_bf16_f32 v48, v44, v45
    v_cvt_pk_bf16_f32 v49, v46, v47
    v_lshlrev_b32 v44, 16, v48
    v_and_b32 v45, 0xffff0000, v48
    v_lshlrev_b32 v46, 16, v49
    v_and_b32 v47, 0xffff0000, v49
    v_pk_mul_f32 v[44:45], v[44:45], s[52:53]
    v_pk_mul_f32 v[46:47], v[46:47], s[52:53]
    v_cvt_pk_bf16_f32 v48, v44, v45
    v_cvt_pk_bf16_f32 v49, v46, v47
    v_lshlrev_b32 v44, 16, v48
    v_and_b32 v45, 0xffff0000, v48
    v_lshlrev_b32 v46, 16, v49
    v_and_b32 v47, 0xffff0000, v49
    v_max3_f32 v50, v50, v44, v45
    v_max3_f32 v50, v50, v46, v47
    v_mov_b32 v51, v50
    s_nop 1
    v_permlane16_swap_b32 v50, v51
    v_max_f32 v50, v50, v51
    v_mov_b32 v51, v50
    s_nop 1
    v_permlane32_swap_b32 v50, v51
    v_max_f32 v50, v50, v51
    v_mul_f32 v50, s56, v50
    v_ceil_f32 v50, v50
    v_fma_f32 v40, v40, s56, -v50
    v_fma_f32 v41, v41, s56, -v50
    v_fma_f32 v42, v42, s56, -v50
    v_fma_f32 v43, v43, s56, -v50
    v_fma_f32 v44, v44, s56, -v50
    v_fma_f32 v45, v45, s56, -v50
    v_fma_f32 v46, v46, s56, -v50
    v_fma_f32 v47, v47, s56, -v50
    v_mul_f32 v52, 0x43000000, v50
    v_exp_f32 v40, v40
    v_exp_f32 v41, v41
    v_exp_f32 v42, v42
    v_exp_f32 v43, v43
    v_exp_f32 v44, v44
    v_exp_f32 v45, v45
    v_exp_f32 v46, v46
    v_exp_f32 v47, v47
    ds_write_b32 v11, v52
    v_cvt_pk_bf16_f32 v48, v40, v41
    v_cvt_pk_bf16_f32 v49, v42, v43
    v_cvt_pk_bf16_f32 v50, v44, v45
    v_cvt_pk_bf16_f32 v51, v46, v47
    ds_write_b128 v13, v[48:51]
    v_pk_add_f32 v[40:41], v[40:41], v[42:43]
    v_pk_add_f32 v[44:45], v[44:45], v[46:47]
    v_pk_add_f32 v[40:41], v[40:41], v[44:45]
    v_add_f32 v40, v40, v41
    ds_write_b32 v16, v40
    s_waitcnt lgkmcnt(0)
    s_barrier
    ds_read_b128 v[48:51], v10
    ds_read_b128 v[64:67], v12 offset:0
    ds_read_b128 v[68:71], v12 offset:1024
    ds_read_b128 v[72:75], v12 offset:2048
    ds_read_b128 v[76:79], v12 offset:3072
    ds_read_b128 v[80:83], v15 offset:0
    ds_read_b128 v[84:87], v15 offset:16
    ds_read_b128 v[88:91], v15 offset:32
    ds_read_b128 v[92:95], v15 offset:48
    s_mov_b32 s42, 0xbc000000
    s_waitcnt lgkmcnt(8)
    v_max3_f32 v52, v48, v49, v50
    v_max_f32 v52, v52, v51
    v_sub_f32 v40, v52, v48
    v_sub_f32 v41, v52, v49
    v_cvt_u32_f32 v44, v40
    v_cvt_u32_f32 v45, v41
    v_cvt_pk_u16_u32 v44, v44, v45
    s_waitcnt lgkmcnt(4)
    v_pk_sub_u16 v64, v64, v44 op_sel_hi:[1,0] clamp
    v_pk_sub_u16 v65, v65, v44 op_sel_hi:[1,0] clamp
    v_pk_sub_u16 v66, v66, v44 op_sel_hi:[1,0] clamp
    v_pk_sub_u16 v67, v67, v44 op_sel_hi:[1,0] clamp
    v_sub_f32 v42, v52, v50
    v_sub_f32 v43, v52, v51
    v_mfma_f32_16x16x32_bf16 v[96:99], v[64:67], a[0:3], 0
    v_pk_sub_u16 v68, v68, v44 op_sel:[0,1] clamp
    v_pk_sub_u16 v69, v69, v44 op_sel:[0,1] clamp
    v_mfma_f32_16x16x32_bf16 v[100:103], v[64:67], a[4:7], 0
    v_pk_sub_u16 v70, v70, v44 op_sel:[0,1] clamp
    v_pk_sub_u16 v71, v71, v44 op_sel:[0,1] clamp
    v_mfma_f32_16x16x32_bf16 v[104:107], v[64:67], a[8:11], 0
    v_cvt_u32_f32 v46, v42
    v_cvt_u32_f32 v47, v43
    v_mfma_f32_16x16x32_bf16 v[108:111], v[64:67], a[12:15], 0
    v_cvt_pk_u16_u32 v45, v46, v47
    v_pk_sub_u16 v72, v72, v45 op_sel_hi:[1,0] clamp
    v_mfma_f32_16x16x32_bf16 v[112:115], v[64:67], a[16:19], 0
    v_pk_sub_u16 v73, v73, v45 op_sel_hi:[1,0] clamp
    v_pk_sub_u16 v74, v74, v45 op_sel_hi:[1,0] clamp
    v_mfma_f32_16x16x32_bf16 v[116:119], v[64:67], a[20:23], 0
    v_pk_sub_u16 v75, v75, v45 op_sel_hi:[1,0] clamp
    v_pk_sub_u16 v76, v76, v45 op_sel:[0,1] clamp
    v_mfma_f32_16x16x32_bf16 v[120:123], v[64:67], a[24:27], 0
    v_pk_sub_u16 v77, v77, v45 op_sel:[0,1] clamp
    v_pk_sub_u16 v78, v78, v45 op_sel:[0,1] clamp
    v_mfma_f32_16x16x32_bf16 v[124:127], v[64:67], a[28:31], 0
    v_pk_sub_u16 v79, v79, v45 op_sel:[0,1] clamp
    s_waitcnt lgkmcnt(0)
    v_mfma_f32_16x16x32_bf16 v[96:99], v[68:71], a[32:35], v[96:99]
    v_mul_f32 v40, s42, v40
    v_mul_f32 v41, s42, v41
    v_mfma_f32_16x16x32_bf16 v[100:103], v[68:71], a[36:39], v[100:103]
    v_mul_f32 v42, s42, v42
    v_mul_f32 v43, s42, v43
    v_mfma_f32_16x16x32_bf16 v[104:107], v[68:71], a[40:43], v[104:107]
    v_exp_f32 v40, v40
    v_mfma_f32_16x16x32_bf16 v[108:111], v[68:71], a[44:47], v[108:111]
    v_exp_f32 v41, v41
    v_mfma_f32_16x16x32_bf16 v[112:115], v[68:71], a[48:51], v[112:115]
    v_exp_f32 v42, v42
    v_mfma_f32_16x16x32_bf16 v[116:119], v[68:71], a[52:55], v[116:119]
    v_exp_f32 v43, v43
    v_mfma_f32_16x16x32_bf16 v[120:123], v[68:71], a[56:59], v[120:123]
    v_add_f32 v80, v80, v81
    v_add_f32 v82, v82, v83
    v_mfma_f32_16x16x32_bf16 v[124:127], v[68:71], a[60:63], v[124:127]
    v_add_f32 v84, v84, v85
    v_add_f32 v86, v86, v87
    v_mfma_f32_16x16x32_bf16 v[96:99], v[72:75], a[64:67], v[96:99]
    v_add_f32 v88, v88, v89
    v_add_f32 v90, v90, v91
    v_mfma_f32_16x16x32_bf16 v[100:103], v[72:75], a[68:71], v[100:103]
    v_add_f32 v92, v92, v93
    v_add_f32 v94, v94, v95
    v_mfma_f32_16x16x32_bf16 v[104:107], v[72:75], a[72:75], v[104:107]
    v_add_f32 v80, v80, v82
    v_add_f32 v84, v84, v86
    v_mfma_f32_16x16x32_bf16 v[108:111], v[72:75], a[76:79], v[108:111]
    v_add_f32 v88, v88, v90
    v_add_f32 v92, v92, v94
    buffer_load_dword v58, v56, s[24:27], s48 offen sc1
    v_mfma_f32_16x16x32_bf16 v[112:115], v[72:75], a[80:83], v[112:115]
    v_mul_f32 v53, v80, v40
    v_fmac_f32 v53, v84, v41
    v_mfma_f32_16x16x32_bf16 v[116:119], v[72:75], a[84:87], v[116:119]
    v_fmac_f32 v53, v88, v42
    v_fmac_f32 v53, v92, v43
    v_mfma_f32_16x16x32_bf16 v[120:123], v[72:75], a[88:91], v[120:123]
    v_mul_f32 v52, s42, v52
    v_sub_f32 v52, 0, v52
    v_mfma_f32_16x16x32_bf16 v[124:127], v[72:75], a[92:95], v[124:127]
    v_mov_b32 v54, s40
    v_mfma_f32_16x16x32_bf16 v[96:99], v[76:79], a[96:99], v[96:99]
    s_cmp_lg_u32 s3, 0
    s_cbranch_scc1 W0_21
    s_mov_b32 exec_hi, 0
    buffer_store_dwordx4 v[52:55], v63, s[24:27], s57 offen sc1
    s_mov_b32 exec_hi, -1
W0_21:
    v_mfma_f32_16x16x32_bf16 v[100:103], v[76:79], a[100:103], v[100:103]
    s_nop 2
    v_mfma_f32_16x16x32_bf16 v[104:107], v[76:79], a[104:107], v[104:107]
    s_nop 2
    v_mfma_f32_16x16x32_bf16 v[108:111], v[76:79], a[108:111], v[108:111]
    v_cvt_pk_bf16_f32 v128, v96, v100
    v_cvt_pk_bf16_f32 v132, v97, v101
    v_cvt_pk_bf16_f32 v136, v98, v102
    v_mfma_f32_16x16x32_bf16 v[112:115], v[76:79], a[112:115], v[112:115]
    v_cvt_pk_bf16_f32 v140, v99, v103
    s_nop 1
    v_mfma_f32_16x16x32_bf16 v[116:119], v[76:79], a[116:119], v[116:119]
    v_cvt_pk_bf16_f32 v129, v104, v108
    v_cvt_pk_bf16_f32 v133, v105, v109
    v_cvt_pk_bf16_f32 v137, v106, v110
    v_mfma_f32_16x16x32_bf16 v[120:123], v[76:79], a[120:123], v[120:123]
    v_cvt_pk_bf16_f32 v141, v107, v111
    s_nop 1
    v_mfma_f32_16x16x32_bf16 v[124:127], v[76:79], a[124:127], v[124:127]
    v_cvt_pk_bf16_f32 v130, v112, v116
    v_cvt_pk_bf16_f32 v134, v113, v117
    v_cvt_pk_bf16_f32 v138, v114, v118
    v_cvt_pk_bf16_f32 v142, v115, v119
    v_add3_u32 v144, v128, v129, s40
    v_add3_u32 v145, v132, v133, s40
    v_add3_u32 v146, v136, v137, s40
    v_add3_u32 v147, v140, v141, s40
    v_cvt_pk_bf16_f32 v131, v120, v124
    buffer_store_dwordx4 v[128:131], v61, s[24:27], s36 offen sc1
    v_add3_u32 v144, v130, v131, v144
    buffer_store_dword v144, v62, s[24:27], s64 offen sc1
    v_cvt_pk_bf16_f32 v135, v121, v125
    buffer_store_dwordx4 v[132:135], v61, s[24:27], s37 offen sc1
    v_add3_u32 v145, v134, v135, v145
    buffer_store_dword v145, v62, s[24:27], s65 offen sc1
    v_cvt_pk_bf16_f32 v139, v122, v126
    buffer_store_dwordx4 v[136:139], v61, s[24:27], s38 offen sc1
    v_add3_u32 v146, v138, v139, v146
    buffer_store_dword v146, v62, s[24:27], s66 offen sc1
    v_cvt_pk_bf16_f32 v143, v123, v127
    buffer_store_dwordx4 v[140:143], v61, s[24:27], s39 offen sc1
    v_add3_u32 v147, v142, v143, v147
    buffer_store_dword v147, v62, s[24:27], s67 offen sc1
    v_mov_b32 v211, v59
    s_lshl_b32 s58, s4, 2
    s_add_u32 s58, s58, s5
    v_lshlrev_b32 v210, 14, v1
    s_lshl_b32 s6, s58, 7
    s_add_u32 s65, s6, 196608
    s_cmp_ge_u32 s4, 27
    s_cbranch_scc1 Y_NOF
    s_mul_i32 s7, s3, 2560
    v_add_u32 v22, s7, v14
    v_lshlrev_b32 v23, 4, v0
    s_mul_i32 s7, s58, 2560
    s_add_u32 s66, s7, 1048576
    v_cmp_gt_u32 vcc, 160, v0
    s_mov_b64 s[46:47], vcc
    s_waitcnt vmcnt(9)
    s_cmp_eq_u32 s3, 0
    s_cbranch_scc1 Y_GW
    s_waitcnt vmcnt(8)
Y_GW:
    v_mov_b32 v64, v58
    v_xor_b32 v9, s40, v58
    v_and_b32 v9, v8, v9
    v_cmp_ne_u32 vcc, 0, v9
    s_cbranch_vccz Y_GOK
    s_mov_b32 s50, 40
PA_22:
    buffer_load_dword v64, v56, s[24:27], s48 offen sc1
    s_sub_u32 s41, s41, 1
    s_cmp_lt_i32 s41, 0
    s_cbranch_scc1 PD_23
    s_waitcnt vmcnt(0)
    v_xor_b32 v9, s40, v64
    v_and_b32 v9, v8, v9
    v_cmp_ne_u32 vcc, 0, v9
    s_cbranch_vccz PD_23
    s_sub_u32 s50, s50, 1
    s_cbranch_scc0 PA_22
    s_mov_b32 s50, 40
    buffer_load_dword v64, v56, s[24:27], s49 offen sc1
    s_waitcnt vmcnt(0)
    v_xor_b32 v9, s40, v64
    v_and_b32 v9, v8, v9
    v_cmp_ne_u32 vcc, 0, v9
    s_cbranch_vccnz PA_22
PD_23:
Y_GOK:
    s_mov_b32 s54, 0
Y_GO2:
    s_cmp_lg_u32 s3, 0
    s_cbranch_scc1 W0_24
    s_lshl_b32 s7, s58, 7
    s_add_u32 s7, s7, 69632
    s_mov_b64 exec, 1
    buffer_store_dword v211, v18, s[24:27], s7 offen sc1
    s_mov_b64 exec, -1
W0_24:
    v_add_f32_dpp v64, v64, v64 row_ror:2 row_mask:0xf bank_mask:0xf
    s_nop 1
    v_add_f32_dpp v64, v64, v64 row_ror:4 row_mask:0xf bank_mask:0xf
    v_cvt_pk_bf16_f32 v64, v64, v64
    v_and_b32 v64, 0xffff0000, v64
    s_nop 1
    v_mov_b32_dpp v65, v64 quad_perm:[1,1,3,3] row_mask:0xf bank_mask:0xf
    v_mov_b32_dpp v64, v64 quad_perm:[0,0,2,2] row_mask:0xf bank_mask:0xf
    v_mul_f32 v66, v64, v64
    v_mov_b32 v67, 0x3d372713
    v_fma_f32 v66, v66, v67, 1.0
    v_mul_f32 v66, v66, v64
    v_mul_f32 v66, 0xc0135761, v66
    v_exp_f32 v66, v66
    s_nop 0
    v_add_f32 v66, 1.0, v66
    v_rcp_f32 v66, v66
    s_nop 0
    v_mul_f32 v64, v64, v66
    v_cvt_pk_bf16_f32 v64, v64, v64
    v_and_b32 v64, 0xffff0000, v64
    v_mul_f32 v64, v64, v65
    v_cvt_pk_bf16_f32 v64, v64, v64
    v_and_b32 v40, v64, v4
    v_and_b32 v41, v64, v5
    v_and_b32 v42, v64, v6
    v_and_b32 v43, v64, v7
    s_nop 1
    v_mfma_f32_16x16x32_bf16 v[96:99], v[40:43], a[128:131], 0
    v_mfma_f32_16x16x32_bf16 v[100:103], v[40:43], a[132:135], 0
    v_mfma_f32_16x16x32_bf16 v[104:107], v[40:43], a[136:139], 0
    v_mfma_f32_16x16x32_bf16 v[108:111], v[40:43], a[140:143], 0
    v_mfma_f32_16x16x32_bf16 v[112:115], v[40:43], a[144:147], 0
    s_cmp_lg_u32 s54, 0
    s_cbranch_scc1 Y_WOD
    buffer_load_dwordx4 v[160:163], v55, s[32:35], s30 offen offset:0
    buffer_load_dwordx4 v[164:167], v55, s[32:35], s30 offen offset:256
    buffer_load_dwordx4 v[168:171], v55, s[32:35], s30 offen offset:512
    buffer_load_dwordx4 v[172:175], v55, s[32:35], s30 offen offset:768
    buffer_load_dwordx4 v[176:179], v55, s[32:35], s30 offen offset:1024
    buffer_load_dwordx4 v[180:183], v55, s[32:35], s31 offen offset:0
    buffer_load_dwordx4 v[184:187], v55, s[32:35], s31 offen offset:256
    buffer_load_dwordx4 v[188:191], v55, s[32:35], s31 offen offset:512
    buffer_load_dwordx4 v[192:195], v55, s[32:35], s31 offen offset:768
    buffer_load_dwordx4 v[196:199], v55, s[32:35], s31 offen offset:1024
Y_WOD:
    s_nop 5
    ds_write_b128 v22, v[96:99] offset:8192
    ds_write_b128 v22, v[100:103] offset:8704
    ds_write_b128 v22, v[104:107] offset:9216
    ds_write_b128 v22, v[108:111] offset:9728
    ds_write_b128 v22, v[112:115] offset:10240
    s_waitcnt lgkmcnt(0)
    s_barrier
    s_mov_b64 exec, s[46:47]
    s_cbranch_execz RF_25
    ds_read_b128 v[64:67], v23 offset:8192
    ds_read_b128 v[68:71], v23 offset:10752
    ds_read_b128 v[72:75], v23 offset:13312
    ds_read_b128 v[76:79], v23 offset:15872
    s_waitcnt lgkmcnt(0)
    v_pk_add_f32 v[64:65], v[64:65], v[68:69]
    v_pk_add_f32 v[66:67], v[66:67], v[70:71]
    v_pk_add_f32 v[72:73], v[72:73], v[76:77]
    v_pk_add_f32 v[74:75], v[74:75], v[78:79]
    v_pk_add_f32 v[64:65], v[64:65], v[72:73]
    v_pk_add_f32 v[66:67], v[66:67], v[74:75]
    v_bfi_b32 v64, v8, s40, v64
    v_bfi_b32 v65, v8, s40, v65
    v_bfi_b32 v66, v8, s40, v66
    v_bfi_b32 v67, v8, s40, v67
    buffer_store_dwordx4 v[64:67], v23, s[24:27], s66 offen sc1
RF_25:
    s_mov_b64 exec, -1
    s_branch Y_O
Y_NOF:
    buffer_load_dwordx4 v[160:163], v55, s[32:35], s30 offen offset:0
    buffer_load_dwordx4 v[164:167], v55, s[32:35], s30 offen offset:256
    buffer_load_dwordx4 v[168:171], v55, s[32:35], s30 offen offset:512
    buffer_load_dwordx4 v[172:175], v55, s[32:35], s30 offen offset:768
    buffer_load_dwordx4 v[176:179], v55, s[32:35], s30 offen offset:1024
    buffer_load_dwordx4 v[180:183], v55, s[32:35], s31 offen offset:0
    buffer_load_dwordx4 v[184:187], v55, s[32:35], s31 offen offset:256
    buffer_load_dwordx4 v[188:191], v55, s[32:35], s31 offen offset:512
    buffer_load_dwordx4 v[192:195], v55, s[32:35], s31 offen offset:768
    buffer_load_dwordx4 v[196:199], v55, s[32:35], s31 offen offset:1024
Y_O:
    s_mul_i32 s7, s3, 2560
    v_add_u32 v22, s7, v14
    v_lshlrev_b32 v23, 4, v0
    s_mul_i32 s7, s58, 2560
    s_add_u32 s66, s7, 1376256
    v_cmp_gt_u32 vcc, 160, v0
    s_mov_b64 s[46:47], vcc
    s_mov_b32 s50, 40
PA_26:
    buffer_load_dwordx2 v[64:65], v57, s[24:27], s28 offen sc1
    s_sub_u32 s41, s41, 1
    s_cmp_lt_i32 s41, 0
    s_cbranch_scc1 PD_27
    s_waitcnt vmcnt(0)
    v_xor_b32 v9, s40, v64
    v_bitop3_b32 v9, v9, v65, s40 bitop3:0xf6
    v_and_b32 v9, v8, v9
    v_cmp_ne_u32 vcc, 0, v9
    s_cbranch_vccz PD_27
    s_sub_u32 s50, s50, 1
    s_cbranch_scc0 PA_26
    s_mov_b32 s50, 40
    buffer_load_dwordx2 v[64:65], v57, s[24:27], s29 offen sc1
    s_waitcnt vmcnt(0)
    v_xor_b32 v9, s40, v64
    v_bitop3_b32 v9, v9, v65, s40 bitop3:0xf6
    v_and_b32 v9, v8, v9
    v_cmp_ne_u32 vcc, 0, v9
    s_cbranch_vccnz PA_26
PD_27:
    v_add_f32_dpp v64, v64, v64 row_ror:8 row_mask:0xf bank_mask:0xf
    v_add_f32_dpp v65, v65, v65 row_ror:8 row_mask:0xf bank_mask:0xf
    s_nop 0
    v_add_f32_dpp v64, v64, v64 row_ror:4 row_mask:0xf bank_mask:0xf
    v_add_f32_dpp v65, v65, v65 row_ror:4 row_mask:0xf bank_mask:0xf
    s_nop 0
    v_add_f32_dpp v64, v64, v64 row_ror:2 row_mask:0xf bank_mask:0xf
    v_add_f32_dpp v65, v65, v65 row_ror:2 row_mask:0xf bank_mask:0xf
    s_nop 0
    v_add_f32_dpp v64, v64, v64 row_ror:1 row_mask:0xf bank_mask:0xf
    v_add_f32_dpp v65, v65, v65 row_ror:1 row_mask:0xf bank_mask:0xf
    v_cvt_pk_bf16_f32 v64, v64, v64
    v_cvt_pk_bf16_f32 v65, v65, v65
    v_and_b32 v40, v64, v4
    v_and_b32 v41, v64, v5
    v_and_b32 v42, v64, v6
    v_and_b32 v43, v64, v7
    v_and_b32 v44, v65, v4
    v_and_b32 v45, v65, v5
    v_and_b32 v46, v65, v6
    v_and_b32 v47, v65, v7
    s_nop 0
    v_mfma_f32_16x16x32_bf16 v[96:99], v[40:43], v[160:163], 0
    v_mfma_f32_16x16x32_bf16 v[96:99], v[44:47], v[180:183], v[96:99]
    v_mfma_f32_16x16x32_bf16 v[100:103], v[40:43], v[164:167], 0
    v_mfma_f32_16x16x32_bf16 v[100:103], v[44:47], v[184:187], v[100:103]
    v_mfma_f32_16x16x32_bf16 v[104:107], v[40:43], v[168:171], 0
    v_mfma_f32_16x16x32_bf16 v[104:107], v[44:47], v[188:191], v[104:107]
    v_mfma_f32_16x16x32_bf16 v[108:111], v[40:43], v[172:175], 0
    v_mfma_f32_16x16x32_bf16 v[108:111], v[44:47], v[192:195], v[108:111]
    v_mfma_f32_16x16x32_bf16 v[112:115], v[40:43], v[176:179], 0
    v_mfma_f32_16x16x32_bf16 v[112:115], v[44:47], v[196:199], v[112:115]
    s_or_b32 s7, s3, s5
    s_cbranch_scc1 QF_28
    s_mov_b64 exec, 0xff
    buffer_store_dword v211, v210, s[24:27], s65 offen sc1
    s_mov_b64 exec, -1
QF_28:
    s_nop 1
    ds_write_b128 v22, v[96:99] offset:20480
    ds_write_b128 v22, v[100:103] offset:20992
    ds_write_b128 v22, v[104:107] offset:21504
    s_nop 1
    ds_write_b128 v22, v[108:111] offset:22016
    s_nop 1
    ds_write_b128 v22, v[112:115] offset:22528
    s_waitcnt lgkmcnt(0)
    s_barrier
    s_mov_b64 exec, s[46:47]
    s_cbranch_execz RF_29
    ds_read_b128 v[64:67], v23 offset:20480
    ds_read_b128 v[68:71], v23 offset:23040
    ds_read_b128 v[72:75], v23 offset:25600
    ds_read_b128 v[76:79], v23 offset:28160
    s_waitcnt lgkmcnt(0)
    v_pk_add_f32 v[64:65], v[64:65], v[68:69]
    v_pk_add_f32 v[66:67], v[66:67], v[70:71]
    v_pk_add_f32 v[72:73], v[72:73], v[76:77]
    v_pk_add_f32 v[74:75], v[74:75], v[78:79]
    v_pk_add_f32 v[64:65], v[64:65], v[72:73]
    v_pk_add_f32 v[66:67], v[66:67], v[74:75]
    v_bfi_b32 v64, v8, s40, v64
    v_bfi_b32 v65, v8, s40, v65
    v_bfi_b32 v66, v8, s40, v66
    v_bfi_b32 v67, v8, s40, v67
    buffer_store_dwordx4 v[64:67], v23, s[24:27], s66 offen sc1
RF_29:
    s_mov_b64 exec, -1
L_END:
    s_endpgm
L_CODE_END:
.section .rodata,"a"
.p2align 6
.amdhsa_kernel recurrent_scan__compressed_kv_cla__geglu_ffn__decode_kernel
  .amdhsa_next_free_vgpr 408
  .amdhsa_next_free_sgpr 102
  .amdhsa_accum_offset 256
  .amdhsa_group_segment_fixed_size 0
  .amdhsa_kernarg_size 104
  .amdhsa_user_sgpr_count 2
  .amdhsa_user_sgpr_kernarg_segment_ptr 1
  .amdhsa_system_sgpr_workgroup_id_x 1
.end_amdhsa_kernel
```
